```python
import torch

def _softmax(x, axis=-1):
    return torch.softmax(x, dim=axis)
def _gelu(x):
    return torch.nn.functional.gelu(x, approximate="tanh")
def _silu(x):
    return torch.nn.functional.silu(x)
def _sigmoid(x):
    return torch.sigmoid(x)
def _layernorm(x, axis=-1, eps=1e-5):
    m = x.mean(dim=axis, keepdim=True)
    v = x.var(dim=axis, keepdim=True, unbiased=False)
    return (x - m) / torch.sqrt(v + eps)
def _scatter_add(tgt, idx, src, axis=0):
    return tgt.clone().index_add_(axis, idx, src)
def _segment_sum(src, seg, n):
    out = torch.zeros((n,) + src.shape[1:], dtype=src.dtype)
    return out.index_add_(0, seg, src)
def _pad(x, pw):
    flat = tuple(v for pair in reversed(pw) for v in pair)
    return torch.nn.functional.pad(x, flat)

kernel_name = 'recurrent_scan__mha_block_cached__geglu_ffn__decode'

def setup_inputs():

    _w = (lambda a: (lambda t: t.to(torch.bfloat16) if t.is_floating_point() else t)(torch.as_tensor(a)))
    def _A_setup():
        B, Sq, D = 4, 1, 640
        H, Sk, Dh = 32, 8192, 192
        return {
            "x": _w((lambda *s: torch.randn(*s, dtype=torch.bfloat16) * 0.05)(B, Sq, D)),
            "k_cache": _w((lambda *s: torch.randn(*s, dtype=torch.bfloat16) * 1.6)(B, H, Sk, Dh)),
            "v_cache": _w((lambda *s: torch.randn(*s, dtype=torch.bfloat16) * 0.2)(B, H, Sk, Dh)),
            "wq": _w((lambda *s: torch.randn(*s, dtype=torch.bfloat16) * 1.6)(D, H * Dh) * (D ** -0.5)),
            "wo": _w((lambda *s: torch.randn(*s, dtype=torch.bfloat16) * 0.2)(H * Dh, D) * ((H * Dh) ** -0.5)),
        }
    _A_in = _A_setup()

    def _B_setup():
        B, S, D, F = 4, 1, 640, 1536
        return {
            "x": _w((lambda *s: torch.randn(*s, dtype=torch.bfloat16) * 0.05)(B, S, D)),
            "w_gate": _w((lambda *s: torch.randn(*s, dtype=torch.bfloat16) * 0.1)(D, F)),
            "w_up": _w((lambda *s: torch.randn(*s, dtype=torch.bfloat16) * 0.1)(D, F)),
            "w_down": _w((lambda *s: torch.randn(*s, dtype=torch.bfloat16) * 0.1)(F, D)),
        }
    _B_in = _B_setup()

    return {
        "A_x": _A_in["x"],
        "A_k_cache": _A_in["k_cache"],
        "A_v_cache": _A_in["v_cache"],
        "A_wq": _A_in["wq"],
        "A_wo": _A_in["wo"],
        "B_x": _B_in["x"],
        "B_w_gate": _B_in["w_gate"],
        "B_w_up": _B_in["w_up"],
        "B_w_down": _B_in["w_down"],
    }

def reference(A_x, A_k_cache, A_v_cache, A_wq, A_wo, B_x, B_w_gate, B_w_up, B_w_down):
    def _A_ref(x, k_cache, v_cache, wq, wo):
        B, Sq, D = x.shape
        H, Dh = 32, 192
        q = (lambda x, *d: x.permute(*d))((x @ wq).reshape(B, Sq, H, Dh), 0, 2, 1, 3)
        scores = torch.einsum("bhqd,bhkd->bhqk", q, k_cache) * (Dh ** -0.5)
        p = _softmax(scores, axis=-1)
        o = torch.einsum("bhqk,bhkd->bhqd", p, v_cache)
        return (lambda x, *d: x.permute(*d))(o, 0, 2, 1, 3).reshape(B, Sq, H * Dh) @ wo

    def _B_ref(x, w_gate, w_up, w_down):
        return (_gelu(x @ w_gate) * (x @ w_up)) @ w_down

    x = A_x
    xn = _layernorm(x, axis=-1)
    s = _A_ref(xn, A_k_cache, A_v_cache, A_wq, A_wo)
    g = _silu(_B_ref(xn, B_w_gate, B_w_up, B_w_down))
    return x + s * g
```

```asm
; @launch grid=(256,1,1) block=(512,1,1) lds=118784
.amdgcn_target "amdgcn-amd-amdhsa--gfx950"
.text
.globl recurrent_scan__mha_block_cached__geglu_ffn__decode_kernel
.p2align 8
.type recurrent_scan__mha_block_cached__geglu_ffn__decode_kernel,@function
recurrent_scan__mha_block_cached__geglu_ffn__decode_kernel:
  s_cmp_ge_u32 s2, 256
  s_cbranch_scc1 L_exit_1
  s_load_dwordx16 s[16:31], s[0:1], 0
  s_load_dwordx8 s[32:39], s[0:1], 64
  v_and_b32 v1, 63, v0
  v_lshrrev_b32 v2, 6, v0
  s_nop 0
  v_readfirstlane_b32 s42, v2
  s_lshr_b32 s40, s2, 3
  s_and_b32 s41, s2, 7
  s_mov_b32 s68, 0x01000100
  s_mov_b32 s69, 0x03020302
  s_mov_b32 s70, 0xffff0000
  v_and_b32 v2, 1, v1
  v_cmp_eq_u32 vcc, 1, v2
  v_mov_b32 v3, 0xffff
  v_mov_b32 v4, s70
  v_cndmask_b32 v3, v3, v4, vcc
  v_bfe_u32 v2, v1, 1, 2
  v_cmp_eq_u32 vcc, 0, v2
  s_nop 1
  v_cndmask_b32 v9, 0, v3, vcc
  v_cmp_eq_u32 vcc, 1, v2
  s_nop 1
  v_cndmask_b32 v10, 0, v3, vcc
  v_cmp_eq_u32 vcc, 2, v2
  s_nop 1
  v_cndmask_b32 v11, 0, v3, vcc
  v_cmp_eq_u32 vcc, 3, v2
  s_nop 1
  v_cndmask_b32 v12, 0, v3, vcc
  s_waitcnt lgkmcnt(0)
  v_mov_b32 v15, 4194304
  global_load_dword v15, v15, s[38:39] sc1
  s_cmp_lt_u32 s40, 24
  s_cselect_b32 s63, 5, 3
  s_cmp_lt_u32 s41, s63
  s_cselect_b32 s63, 1, 0
  s_cmp_eq_u32 s42, 7
  s_cselect_b32 s51, 1, 0
  s_cmp_lt_u32 s40, 24
  s_cselect_b32 s51, s51, 0
  s_cmp_eq_u32 s63, 0
  s_cbranch_scc1 L_np0_2
  s_cmp_ge_u32 s42, 4
  s_cbranch_scc1 L_ws_3
  s_mul_i32 s3, s42, 1280
  v_lshlrev_b32 v21, 2, v1
  v_add_u32 v21, s3, v21
  global_load_dword v16, v21, s[16:17] offset:0
  global_load_dword v17, v21, s[16:17] offset:256
  global_load_dword v18, v21, s[16:17] offset:512
  global_load_dword v19, v21, s[16:17] offset:768
  global_load_dword v20, v21, s[16:17] offset:1024
L_ws_3:
  s_cmp_lt_u32 s41, 3
  s_cbranch_scc1 L_tq_4
  s_cmp_eq_u32 s41, 3
  s_cselect_b32 s54, s28, s30
  s_cselect_b32 s55, s29, s31
  s_mov_b32 s56, 3072
  s_lshl_b32 s57, s40, 7
  s_branch L_tsel_6
L_tq_4:
  s_mov_b32 s54, s22
  s_mov_b32 s55, s23
  s_mov_b32 s56, 12288
  s_mul_i32 s57, s40, 384
  s_lshl_b32 s3, s41, 7
  s_add_u32 s57, s57, s3
L_tsel_6:
  v_lshrrev_b32 v104, 3, v1
  v_mul_lo_u32 v104, v104, s56
  v_and_b32 v105, 7, v1
  v_lshlrev_b32 v105, 4, v105
  v_add_u32 v104, v104, v105
  s_mul_i32 s3, s42, 80
  s_mul_i32 s3, s3, s56
  s_add_u32 s3, s3, s57
  v_add_u32 v104, s3, v104
  s_lshl_b32 s57, s56, 3
  s_nop 0
L_np0_2:
  s_cmp_lg_u32 s42, 6
  s_cbranch_scc1 L_ws_7
  v_mov_b32 v16, 6291456
  global_load_dword v16, v16, s[38:39] sc1
  v_mov_b32 v17, 8388608
  global_load_dword v17, v17, s[38:39] sc1
  s_mul_i32 s3, s2, 30720
  v_mov_b32 v18, s3
  global_load_dword v18, v18, s[24:25] nt
  s_mul_i32 s3, s40, 61440
  v_mov_b32 v19, s3
  global_load_dword v19, v19, s[32:33] nt
  s_nop 0
L_ws_7:
  s_cmp_lg_u32 s42, 7
  s_cbranch_scc1 L_ws_8
  v_mov_b32 v16, 13184
  v_mov_b32 v18, 0
  v_mov_b32 v19, 0
  v_mov_b32 v20, 0
  v_mov_b32 v21, 0
  ds_write_b128 v16, v[18:21]
  s_waitcnt lgkmcnt(0)
L_ws_8:
  s_mov_b32 s4, s18
  s_and_b32 s5, s19, 0xffff
  s_mov_b32 s6, 402653184
  s_mov_b32 s7, 0x20000
  s_mov_b32 s8, s20
  s_and_b32 s9, s21, 0xffff
  s_mov_b32 s10, 402653184
  s_mov_b32 s11, 0x20000
  s_mov_b32 s12, s18
  s_and_b32 s13, s19, 0xffff
  s_mov_b32 s14, 0
  s_mov_b32 s15, 0x20000
  v_lshrrev_b32 v2, 3, v1
  v_mul_u32_u24 v2, 384, v2
  v_and_b32 v3, 7, v1
  v_lshlrev_b32 v3, 4, v3
  v_add_u32 v2, v2, v3
  v_add_u32 v3, 3072, v2
  v_add_u32 v4, 6144, v2
  v_add_u32 v5, 9216, v2
  v_mov_b32 v6, 0
  v_mov_b32 v7, 1
  s_mul_i32 s50, s40, 3145728
  s_lshl_b32 s58, s40, 8
  s_add_u32 s58, s58, 4198400
  s_add_u32 s52, s38, s58
  s_addc_u32 s53, s39, 0
  s_mov_b32 s66, 0x3d93cd3a
  s_mov_b32 s67, 0x3fb8aa3b
  s_lshl_b32 s60, s41, 3
  s_add_u32 s60, s60, s42
  s_mov_b32 s44, 1
  s_sub_u32 s43, s60, 304
  s_add_u32 s43, s43, 3584
  s_sub_u32 s58, s60, 240
  s_mul_i32 s58, s58, 4
  s_add_u32 s58, s58, 3328
  s_cmp_lt_u32 s60, 304
  s_cselect_b32 s43, s58, s43
  s_cselect_b32 s44, 4, s44
  s_sub_u32 s58, s60, 176
  s_mul_i32 s58, s58, 8
  s_add_u32 s58, s58, 2816
  s_cmp_lt_u32 s60, 240
  s_cselect_b32 s43, s58, s43
  s_cselect_b32 s44, 8, s44
  s_sub_u32 s58, s60, 0
  s_mul_i32 s58, s58, 16
  s_add_u32 s58, s58, 0
  s_cmp_lt_u32 s60, 176
  s_cselect_b32 s43, s58, s43
  s_cselect_b32 s44, 16, s44
  s_lshr_b32 s49, s43, 10
  s_mul_i32 s58, s49, 100663296
  s_and_b32 s59, s43, 1023
  s_mul_i32 s59, s59, 3072
  s_add_u32 s45, s58, s59
  s_add_u32 s45, s45, s50
  s_mov_b32 s47, s49
  s_add_u32 s43, s43, 8
  s_sub_u32 s44, s44, 8
  s_add_u32 s98, s45, 12288
  s_mov_b32 s72, 0xfffffc00
  s_mov_b32 s74, 0xff000000
  s_cmp_lg_u32 s42, 5
  s_cbranch_scc1 L_ws_9
  s_cmp_lg_u32 s41, 0
  s_cbranch_scc1 L_ws_9
  s_mov_b64 exec, 1
  global_store_dword v6, v6, s[52:53] sc1
  s_mov_b64 exec, -1
L_ws_9:
  s_barrier
  s_cmp_eq_u32 s63, 0
  s_cbranch_scc1 L_nprod_10
  s_cmp_ge_u32 s42, 4
  s_cbranch_scc1 L_p47_11
  global_load_dwordx4 v[64:67], v104, s[54:55] nt
  v_add_u32 v104, s57, v104
  global_load_dwordx4 v[68:71], v104, s[54:55] nt
  v_add_u32 v104, s57, v104
  global_load_dwordx4 v[72:75], v104, s[54:55] nt
  v_add_u32 v104, s57, v104
  global_load_dwordx4 v[76:79], v104, s[54:55] nt
  v_add_u32 v104, s57, v104
  s_waitcnt vmcnt(4)
  v_lshlrev_b32 v48, 16, v16
  v_and_b32 v49, s70, v16
  v_lshlrev_b32 v50, 16, v17
  v_and_b32 v51, s70, v17
  v_lshlrev_b32 v52, 16, v18
  v_and_b32 v53, s70, v18
  v_lshlrev_b32 v54, 16, v19
  v_and_b32 v55, s70, v19
  v_lshlrev_b32 v56, 16, v20
  v_and_b32 v57, s70, v20
  v_add_f32 v58, v48, v49
  v_add_f32 v58, v58, v50
  v_add_f32 v58, v58, v51
  v_add_f32 v58, v58, v52
  v_add_f32 v58, v58, v53
  v_add_f32 v58, v58, v54
  v_add_f32 v58, v58, v55
  v_add_f32 v58, v58, v56
  v_add_f32 v58, v58, v57
  s_nop 1
  v_add_f32_dpp v58, v58, v58 quad_perm:[1,0,3,2] row_mask:0xf bank_mask:0xf
  s_nop 1
  v_add_f32_dpp v58, v58, v58 quad_perm:[2,3,0,1] row_mask:0xf bank_mask:0xf
  s_nop 1
  v_add_f32_dpp v58, v58, v58 row_half_mirror row_mask:0xf bank_mask:0xf
  s_nop 1
  v_add_f32_dpp v58, v58, v58 row_mirror row_mask:0xf bank_mask:0xf
  s_nop 0
  v_readlane_b32 s58, v58, 0
  v_readlane_b32 s59, v58, 16
  v_readlane_b32 s60, v58, 32
  v_readlane_b32 s61, v58, 48
  v_mov_b32 v58, s58
  v_add_f32 v58, s59, v58
  v_add_f32 v58, s60, v58
  v_add_f32 v58, s61, v58
  v_mul_f32 v58, 0x3acccccd, v58
  v_sub_f32 v60, v48, v58
  v_mul_f32 v59, v60, v60
  v_sub_f32 v60, v49, v58
  v_fma_f32 v59, v60, v60, v59
  v_sub_f32 v60, v50, v58
  v_fma_f32 v59, v60, v60, v59
  v_sub_f32 v60, v51, v58
  v_fma_f32 v59, v60, v60, v59
  v_sub_f32 v60, v52, v58
  v_fma_f32 v59, v60, v60, v59
  v_sub_f32 v60, v53, v58
  v_fma_f32 v59, v60, v60, v59
  v_sub_f32 v60, v54, v58
  v_fma_f32 v59, v60, v60, v59
  v_sub_f32 v60, v55, v58
  v_fma_f32 v59, v60, v60, v59
  v_sub_f32 v60, v56, v58
  v_fma_f32 v59, v60, v60, v59
  v_sub_f32 v60, v57, v58
  v_fma_f32 v59, v60, v60, v59
  s_nop 1
  v_add_f32_dpp v59, v59, v59 quad_perm:[1,0,3,2] row_mask:0xf bank_mask:0xf
  s_nop 1
  v_add_f32_dpp v59, v59, v59 quad_perm:[2,3,0,1] row_mask:0xf bank_mask:0xf
  s_nop 1
  v_add_f32_dpp v59, v59, v59 row_half_mirror row_mask:0xf bank_mask:0xf
  s_nop 1
  v_add_f32_dpp v59, v59, v59 row_mirror row_mask:0xf bank_mask:0xf
  s_nop 0
  v_readlane_b32 s58, v59, 0
  v_readlane_b32 s59, v59, 16
  v_readlane_b32 s60, v59, 32
  v_readlane_b32 s61, v59, 48
  v_mov_b32 v59, s58
  v_add_f32 v59, s59, v59
  v_add_f32 v59, s60, v59
  v_add_f32 v59, s61, v59
  v_mul_f32 v59, 0x3acccccd, v59
  v_cvt_pk_bf16_f32 v58, v58, v58
  v_and_b32 v58, s70, v58
  v_cvt_pk_bf16_f32 v59, v59, v59
  v_and_b32 v59, s70, v59
  v_add_f32 v59, 0x3727c5ac, v59
  v_cvt_pk_bf16_f32 v59, v59, v59
  v_and_b32 v59, s70, v59
  v_sqrt_f32 v59, v59
  s_nop 0
  v_cvt_pk_bf16_f32 v59, v59, v59
  v_and_b32 v59, s70, v59
  v_sub_f32 v48, v48, v58
  v_sub_f32 v49, v49, v58
  v_sub_f32 v50, v50, v58
  v_sub_f32 v51, v51, v58
  v_sub_f32 v52, v52, v58
  v_sub_f32 v53, v53, v58
  v_sub_f32 v54, v54, v58
  v_sub_f32 v55, v55, v58
  v_sub_f32 v56, v56, v58
  v_sub_f32 v57, v57, v58
  v_cvt_pk_bf16_f32 v60, v48, v49
  v_lshlrev_b32 v48, 16, v60
  v_and_b32 v49, s70, v60
  v_cvt_pk_bf16_f32 v60, v50, v51
  v_lshlrev_b32 v50, 16, v60
  v_and_b32 v51, s70, v60
  v_cvt_pk_bf16_f32 v60, v52, v53
  v_lshlrev_b32 v52, 16, v60
  v_and_b32 v53, s70, v60
  v_cvt_pk_bf16_f32 v60, v54, v55
  v_lshlrev_b32 v54, 16, v60
  v_and_b32 v55, s70, v60
  v_cvt_pk_bf16_f32 v60, v56, v57
  v_lshlrev_b32 v56, 16, v60
  v_and_b32 v57, s70, v60
  v_rcp_f32 v58, v59
  s_nop 0
  v_mul_f32 v60, v48, v58
  v_fma_f32 v61, -v60, v59, v48
  v_fma_f32 v48, v61, v58, v60
  v_mul_f32 v60, v49, v58
  v_fma_f32 v61, -v60, v59, v49
  v_fma_f32 v49, v61, v58, v60
  v_mul_f32 v60, v50, v58
  v_fma_f32 v61, -v60, v59, v50
  v_fma_f32 v50, v61, v58, v60
  v_mul_f32 v60, v51, v58
  v_fma_f32 v61, -v60, v59, v51
  v_fma_f32 v51, v61, v58, v60
  v_mul_f32 v60, v52, v58
  v_fma_f32 v61, -v60, v59, v52
  v_fma_f32 v52, v61, v58, v60
  v_mul_f32 v60, v53, v58
  v_fma_f32 v61, -v60, v59, v53
  v_fma_f32 v53, v61, v58, v60
  v_mul_f32 v60, v54, v58
  v_fma_f32 v61, -v60, v59, v54
  v_fma_f32 v54, v61, v58, v60
  v_mul_f32 v60, v55, v58
  v_fma_f32 v61, -v60, v59, v55
  v_fma_f32 v55, v61, v58, v60
  v_mul_f32 v60, v56, v58
  v_fma_f32 v61, -v60, v59, v56
  v_fma_f32 v56, v61, v58, v60
  v_mul_f32 v60, v57, v58
  v_fma_f32 v61, -v60, v59, v57
  v_fma_f32 v57, v61, v58, v60
  s_mul_i32 s3, s42, 2560
  v_lshlrev_b32 v62, 3, v1
  v_add_u32 v62, s3, v62
  v_cvt_pk_bf16_f32 v59, v48, v49
  v_perm_b32 v60, v59, v59, s68
  v_perm_b32 v61, v59, v59, s69
  ds_write_b64 v62, v[60:61] offset:0
  v_cvt_pk_bf16_f32 v59, v50, v51
  v_perm_b32 v60, v59, v59, s68
  v_perm_b32 v61, v59, v59, s69
  ds_write_b64 v62, v[60:61] offset:512
  v_cvt_pk_bf16_f32 v59, v52, v53
  v_perm_b32 v60, v59, v59, s68
  v_perm_b32 v61, v59, v59, s69
  ds_write_b64 v62, v[60:61] offset:1024
  v_cvt_pk_bf16_f32 v59, v54, v55
  v_perm_b32 v60, v59, v59, s68
  v_perm_b32 v61, v59, v59, s69
  ds_write_b64 v62, v[60:61] offset:1536
  v_cvt_pk_bf16_f32 v59, v56, v57
  v_perm_b32 v60, v59, v59, s68
  v_perm_b32 v61, v59, v59, s69
  ds_write_b64 v62, v[60:61] offset:2048
  s_waitcnt lgkmcnt(0)
  v_mov_b32 v44, 13184
  v_mov_b32 v45, 1
  s_mov_b64 exec, 1
  ds_add_u32 v44, v45
  s_mov_b64 exec, -1
  global_load_dwordx4 v[80:83], v104, s[54:55] nt
  v_add_u32 v104, s57, v104
  global_load_dwordx4 v[84:87], v104, s[54:55] nt
  v_add_u32 v104, s57, v104
  global_load_dwordx4 v[88:91], v104, s[54:55] nt
  v_add_u32 v104, s57, v104
  global_load_dwordx4 v[92:95], v104, s[54:55] nt
  v_add_u32 v104, s57, v104
  global_load_dwordx4 v[96:99], v104, s[54:55] nt
  v_add_u32 v104, s57, v104
  global_load_dwordx4 v[100:103], v104, s[54:55] nt
  s_nop 0
  s_branch L_pj_12
L_p47_11:
  global_load_dwordx4 v[64:67], v104, s[54:55] nt
  v_add_u32 v104, s57, v104
  global_load_dwordx4 v[68:71], v104, s[54:55] nt
  v_add_u32 v104, s57, v104
  global_load_dwordx4 v[72:75], v104, s[54:55] nt
  v_add_u32 v104, s57, v104
  global_load_dwordx4 v[76:79], v104, s[54:55] nt
  v_add_u32 v104, s57, v104
  global_load_dwordx4 v[80:83], v104, s[54:55] nt
  v_add_u32 v104, s57, v104
  global_load_dwordx4 v[84:87], v104, s[54:55] nt
  v_add_u32 v104, s57, v104
  global_load_dwordx4 v[88:91], v104, s[54:55] nt
  v_add_u32 v104, s57, v104
  global_load_dwordx4 v[92:95], v104, s[54:55] nt
  v_add_u32 v104, s57, v104
  global_load_dwordx4 v[96:99], v104, s[54:55] nt
  v_add_u32 v104, s57, v104
  global_load_dwordx4 v[100:103], v104, s[54:55] nt
  s_nop 0
L_pj_12:
  v_mov_b32 v44, 13184
  s_mov_b32 s58, 0x400000
  s_nop 0
L_lw_13:
  ds_read_b32 v45, v44
  s_waitcnt lgkmcnt(0)
  v_readfirstlane_b32 s3, v45
  s_cmp_eq_u32 s3, 4
  s_nop 3
  s_cbranch_scc1 L_lwd_14
  s_sub_u32 s58, s58, 1
  s_cbranch_scc0 L_lw_13
L_lwd_14:
  v_mov_b32 v160, 0
  v_mov_b32 v161, 0
  v_mov_b32 v162, 0
  v_mov_b32 v163, 0
  v_mov_b32 v164, 0
  v_mov_b32 v165, 0
  v_mov_b32 v166, 0
  v_mov_b32 v167, 0
  v_mov_b32 v168, 0
  v_mov_b32 v169, 0
  v_mov_b32 v170, 0
  v_mov_b32 v171, 0
  v_mov_b32 v172, 0
  v_mov_b32 v173, 0
  v_mov_b32 v174, 0
  v_mov_b32 v175, 0
  s_mul_i32 s3, s42, 320
  v_lshrrev_b32 v220, 3, v1
  v_lshlrev_b32 v220, 2, v220
  v_add_u32 v220, s3, v220
  ds_read_b32 v180, v220 offset:0
  ds_read_b32 v181, v220 offset:2560
  ds_read_b32 v182, v220 offset:5120
  ds_read_b32 v183, v220 offset:7680
  ds_read_b32 v184, v220 offset:32
  ds_read_b32 v185, v220 offset:2592
  ds_read_b32 v186, v220 offset:5152
  ds_read_b32 v187, v220 offset:7712
  ds_read_b32 v188, v220 offset:64
  ds_read_b32 v189, v220 offset:2624
  ds_read_b32 v190, v220 offset:5184
  ds_read_b32 v191, v220 offset:7744
  ds_read_b32 v192, v220 offset:96
  ds_read_b32 v193, v220 offset:2656
  ds_read_b32 v194, v220 offset:5216
  ds_read_b32 v195, v220 offset:7776
  ds_read_b32 v196, v220 offset:128
  ds_read_b32 v197, v220 offset:2688
  ds_read_b32 v198, v220 offset:5248
  ds_read_b32 v199, v220 offset:7808
  ds_read_b32 v200, v220 offset:160
  ds_read_b32 v201, v220 offset:2720
  ds_read_b32 v202, v220 offset:5280
  ds_read_b32 v203, v220 offset:7840
  ds_read_b32 v204, v220 offset:192
  ds_read_b32 v205, v220 offset:2752
  ds_read_b32 v206, v220 offset:5312
  ds_read_b32 v207, v220 offset:7872
  ds_read_b32 v208, v220 offset:224
  ds_read_b32 v209, v220 offset:2784
  ds_read_b32 v210, v220 offset:5344
  ds_read_b32 v211, v220 offset:7904
  ds_read_b32 v212, v220 offset:256
  ds_read_b32 v213, v220 offset:2816
  ds_read_b32 v214, v220 offset:5376
  ds_read_b32 v215, v220 offset:7936
  ds_read_b32 v216, v220 offset:288
  ds_read_b32 v217, v220 offset:2848
  ds_read_b32 v218, v220 offset:5408
  ds_read_b32 v219, v220 offset:7968
  s_waitcnt vmcnt(0) lgkmcnt(0)
  v_and_b32 v176, v180, v9
  v_and_b32 v177, v180, v10
  v_and_b32 v178, v180, v11
  v_and_b32 v179, v180, v12
  s_nop 1
  v_mfma_f32_16x16x32_bf16 v[160:163], v[176:179], v[64:67], v[160:163]
  v_and_b32 v176, v181, v9
  v_and_b32 v177, v181, v10
  v_and_b32 v178, v181, v11
  v_and_b32 v179, v181, v12
  s_nop 1
  v_mfma_f32_16x16x32_bf16 v[164:167], v[176:179], v[64:67], v[164:167]
  v_and_b32 v176, v182, v9
  v_and_b32 v177, v182, v10
  v_and_b32 v178, v182, v11
  v_and_b32 v179, v182, v12
  s_nop 1
  v_mfma_f32_16x16x32_bf16 v[168:171], v[176:179], v[64:67], v[168:171]
  v_and_b32 v176, v183, v9
  v_and_b32 v177, v183, v10
  v_and_b32 v178, v183, v11
  v_and_b32 v179, v183, v12
  s_nop 1
  v_mfma_f32_16x16x32_bf16 v[172:175], v[176:179], v[64:67], v[172:175]
  v_and_b32 v176, v184, v9
  v_and_b32 v177, v184, v10
  v_and_b32 v178, v184, v11
  v_and_b32 v179, v184, v12
  s_nop 1
  v_mfma_f32_16x16x32_bf16 v[160:163], v[176:179], v[68:71], v[160:163]
  v_and_b32 v176, v185, v9
  v_and_b32 v177, v185, v10
  v_and_b32 v178, v185, v11
  v_and_b32 v179, v185, v12
  s_nop 1
  v_mfma_f32_16x16x32_bf16 v[164:167], v[176:179], v[68:71], v[164:167]
  v_and_b32 v176, v186, v9
  v_and_b32 v177, v186, v10
  v_and_b32 v178, v186, v11
  v_and_b32 v179, v186, v12
  s_nop 1
  v_mfma_f32_16x16x32_bf16 v[168:171], v[176:179], v[68:71], v[168:171]
  v_and_b32 v176, v187, v9
  v_and_b32 v177, v187, v10
  v_and_b32 v178, v187, v11
  v_and_b32 v179, v187, v12
  s_nop 1
  v_mfma_f32_16x16x32_bf16 v[172:175], v[176:179], v[68:71], v[172:175]
  v_and_b32 v176, v188, v9
  v_and_b32 v177, v188, v10
  v_and_b32 v178, v188, v11
  v_and_b32 v179, v188, v12
  s_nop 1
  v_mfma_f32_16x16x32_bf16 v[160:163], v[176:179], v[72:75], v[160:163]
  v_and_b32 v176, v189, v9
  v_and_b32 v177, v189, v10
  v_and_b32 v178, v189, v11
  v_and_b32 v179, v189, v12
  s_nop 1
  v_mfma_f32_16x16x32_bf16 v[164:167], v[176:179], v[72:75], v[164:167]
  v_and_b32 v176, v190, v9
  v_and_b32 v177, v190, v10
  v_and_b32 v178, v190, v11
  v_and_b32 v179, v190, v12
  s_nop 1
  v_mfma_f32_16x16x32_bf16 v[168:171], v[176:179], v[72:75], v[168:171]
  v_and_b32 v176, v191, v9
  v_and_b32 v177, v191, v10
  v_and_b32 v178, v191, v11
  v_and_b32 v179, v191, v12
  s_nop 1
  v_mfma_f32_16x16x32_bf16 v[172:175], v[176:179], v[72:75], v[172:175]
  v_and_b32 v176, v192, v9
  v_and_b32 v177, v192, v10
  v_and_b32 v178, v192, v11
  v_and_b32 v179, v192, v12
  s_nop 1
  v_mfma_f32_16x16x32_bf16 v[160:163], v[176:179], v[76:79], v[160:163]
  v_and_b32 v176, v193, v9
  v_and_b32 v177, v193, v10
  v_and_b32 v178, v193, v11
  v_and_b32 v179, v193, v12
  s_nop 1
  v_mfma_f32_16x16x32_bf16 v[164:167], v[176:179], v[76:79], v[164:167]
  v_and_b32 v176, v194, v9
  v_and_b32 v177, v194, v10
  v_and_b32 v178, v194, v11
  v_and_b32 v179, v194, v12
  s_nop 1
  v_mfma_f32_16x16x32_bf16 v[168:171], v[176:179], v[76:79], v[168:171]
  v_and_b32 v176, v195, v9
  v_and_b32 v177, v195, v10
  v_and_b32 v178, v195, v11
  v_and_b32 v179, v195, v12
  s_nop 1
  v_mfma_f32_16x16x32_bf16 v[172:175], v[176:179], v[76:79], v[172:175]
  v_and_b32 v176, v196, v9
  v_and_b32 v177, v196, v10
  v_and_b32 v178, v196, v11
  v_and_b32 v179, v196, v12
  s_nop 1
  v_mfma_f32_16x16x32_bf16 v[160:163], v[176:179], v[80:83], v[160:163]
  v_and_b32 v176, v197, v9
  v_and_b32 v177, v197, v10
  v_and_b32 v178, v197, v11
  v_and_b32 v179, v197, v12
  s_nop 1
  v_mfma_f32_16x16x32_bf16 v[164:167], v[176:179], v[80:83], v[164:167]
  v_and_b32 v176, v198, v9
  v_and_b32 v177, v198, v10
  v_and_b32 v178, v198, v11
  v_and_b32 v179, v198, v12
  s_nop 1
  v_mfma_f32_16x16x32_bf16 v[168:171], v[176:179], v[80:83], v[168:171]
  v_and_b32 v176, v199, v9
  v_and_b32 v177, v199, v10
  v_and_b32 v178, v199, v11
  v_and_b32 v179, v199, v12
  s_nop 1
  v_mfma_f32_16x16x32_bf16 v[172:175], v[176:179], v[80:83], v[172:175]
  v_and_b32 v176, v200, v9
  v_and_b32 v177, v200, v10
  v_and_b32 v178, v200, v11
  v_and_b32 v179, v200, v12
  s_nop 1
  v_mfma_f32_16x16x32_bf16 v[160:163], v[176:179], v[84:87], v[160:163]
  v_and_b32 v176, v201, v9
  v_and_b32 v177, v201, v10
  v_and_b32 v178, v201, v11
  v_and_b32 v179, v201, v12
  s_nop 1
  v_mfma_f32_16x16x32_bf16 v[164:167], v[176:179], v[84:87], v[164:167]
  v_and_b32 v176, v202, v9
  v_and_b32 v177, v202, v10
  v_and_b32 v178, v202, v11
  v_and_b32 v179, v202, v12
  s_nop 1
  v_mfma_f32_16x16x32_bf16 v[168:171], v[176:179], v[84:87], v[168:171]
  v_and_b32 v176, v203, v9
  v_and_b32 v177, v203, v10
  v_and_b32 v178, v203, v11
  v_and_b32 v179, v203, v12
  s_nop 1
  v_mfma_f32_16x16x32_bf16 v[172:175], v[176:179], v[84:87], v[172:175]
  v_and_b32 v176, v204, v9
  v_and_b32 v177, v204, v10
  v_and_b32 v178, v204, v11
  v_and_b32 v179, v204, v12
  s_nop 1
  v_mfma_f32_16x16x32_bf16 v[160:163], v[176:179], v[88:91], v[160:163]
  v_and_b32 v176, v205, v9
  v_and_b32 v177, v205, v10
  v_and_b32 v178, v205, v11
  v_and_b32 v179, v205, v12
  s_nop 1
  v_mfma_f32_16x16x32_bf16 v[164:167], v[176:179], v[88:91], v[164:167]
  v_and_b32 v176, v206, v9
  v_and_b32 v177, v206, v10
  v_and_b32 v178, v206, v11
  v_and_b32 v179, v206, v12
  s_nop 1
  v_mfma_f32_16x16x32_bf16 v[168:171], v[176:179], v[88:91], v[168:171]
  v_and_b32 v176, v207, v9
  v_and_b32 v177, v207, v10
  v_and_b32 v178, v207, v11
  v_and_b32 v179, v207, v12
  s_nop 1
  v_mfma_f32_16x16x32_bf16 v[172:175], v[176:179], v[88:91], v[172:175]
  v_and_b32 v176, v208, v9
  v_and_b32 v177, v208, v10
  v_and_b32 v178, v208, v11
  v_and_b32 v179, v208, v12
  s_nop 1
  v_mfma_f32_16x16x32_bf16 v[160:163], v[176:179], v[92:95], v[160:163]
  v_and_b32 v176, v209, v9
  v_and_b32 v177, v209, v10
  v_and_b32 v178, v209, v11
  v_and_b32 v179, v209, v12
  s_nop 1
  v_mfma_f32_16x16x32_bf16 v[164:167], v[176:179], v[92:95], v[164:167]
  v_and_b32 v176, v210, v9
  v_and_b32 v177, v210, v10
  v_and_b32 v178, v210, v11
  v_and_b32 v179, v210, v12
  s_nop 1
  v_mfma_f32_16x16x32_bf16 v[168:171], v[176:179], v[92:95], v[168:171]
  v_and_b32 v176, v211, v9
  v_and_b32 v177, v211, v10
  v_and_b32 v178, v211, v11
  v_and_b32 v179, v211, v12
  s_nop 1
  v_mfma_f32_16x16x32_bf16 v[172:175], v[176:179], v[92:95], v[172:175]
  v_and_b32 v176, v212, v9
  v_and_b32 v177, v212, v10
  v_and_b32 v178, v212, v11
  v_and_b32 v179, v212, v12
  s_nop 1
  v_mfma_f32_16x16x32_bf16 v[160:163], v[176:179], v[96:99], v[160:163]
  v_and_b32 v176, v213, v9
  v_and_b32 v177, v213, v10
  v_and_b32 v178, v213, v11
  v_and_b32 v179, v213, v12
  s_nop 1
  v_mfma_f32_16x16x32_bf16 v[164:167], v[176:179], v[96:99], v[164:167]
  v_and_b32 v176, v214, v9
  v_and_b32 v177, v214, v10
  v_and_b32 v178, v214, v11
  v_and_b32 v179, v214, v12
  s_nop 1
  v_mfma_f32_16x16x32_bf16 v[168:171], v[176:179], v[96:99], v[168:171]
  v_and_b32 v176, v215, v9
  v_and_b32 v177, v215, v10
  v_and_b32 v178, v215, v11
  v_and_b32 v179, v215, v12
  s_nop 1
  v_mfma_f32_16x16x32_bf16 v[172:175], v[176:179], v[96:99], v[172:175]
  v_and_b32 v176, v216, v9
  v_and_b32 v177, v216, v10
  v_and_b32 v178, v216, v11
  v_and_b32 v179, v216, v12
  s_nop 1
  v_mfma_f32_16x16x32_bf16 v[160:163], v[176:179], v[100:103], v[160:163]
  v_and_b32 v176, v217, v9
  v_and_b32 v177, v217, v10
  v_and_b32 v178, v217, v11
  v_and_b32 v179, v217, v12
  s_nop 1
  v_mfma_f32_16x16x32_bf16 v[164:167], v[176:179], v[100:103], v[164:167]
  v_and_b32 v176, v218, v9
  v_and_b32 v177, v218, v10
  v_and_b32 v178, v218, v11
  v_and_b32 v179, v218, v12
  s_nop 1
  v_mfma_f32_16x16x32_bf16 v[168:171], v[176:179], v[100:103], v[168:171]
  v_and_b32 v176, v219, v9
  v_and_b32 v177, v219, v10
  v_and_b32 v178, v219, v11
  v_and_b32 v179, v219, v12
  s_nop 1
  v_mfma_f32_16x16x32_bf16 v[172:175], v[176:179], v[100:103], v[172:175]
  v_lshrrev_b32 v220, 5, v1
  v_lshlrev_b32 v220, 10, v220
  v_and_b32 v180, 7, v1
  v_lshlrev_b32 v180, 5, v180
  v_add_u32 v220, v220, v180
  v_bfe_u32 v180, v1, 4, 1
  v_lshlrev_b32 v180, 4, v180
  v_add_u32 v220, v220, v180
  s_lshl_b32 s3, s42, 11
  s_add_u32 s3, s3, 73728
  v_add_u32 v220, s3, v220
  s_mov_b32 exec_lo, 0x00ff00ff
  s_mov_b32 exec_hi, 0xff00ff00
  ds_write_b128 v220, v[160:163] offset:0
  ds_write_b128 v220, v[164:167] offset:256
  ds_write_b128 v220, v[168:171] offset:512
  ds_write_b128 v220, v[172:175] offset:768
  s_mov_b64 exec, -1
  v_readfirstlane_b32 s71, v15
  s_add_u32 s71, s71, 1
  s_mul_i32 s73, s71, 0x9e3779b1
  s_and_b32 s73, s73, 0xff000000
  s_waitcnt lgkmcnt(0)
  v_mov_b32 v44, 13188
  v_mov_b32 v45, 1
  s_mov_b64 exec, 1
  ds_add_u32 v44, v45
  s_mov_b64 exec, -1
  s_cmp_lg_u32 s42, 0
  s_cbranch_scc1 L_ws_15
  v_mov_b32 v44, 13188
  s_mov_b32 s58, 0x400000
  s_nop 0
L_lw_16:
  ds_read_b32 v45, v44
  s_waitcnt lgkmcnt(0)
  v_readfirstlane_b32 s3, v45
  s_cmp_eq_u32 s3, 8
  s_nop 3
  s_cbranch_scc1 L_lwd_17
  s_sub_u32 s58, s58, 1
  s_cbranch_scc0 L_lw_16
L_lwd_17:
  v_lshlrev_b32 v160, 4, v1
  v_add_u32 v161, 73728, v160
  ds_read_b128 v[164:167], v161 offset:0
  ds_read_b128 v[168:171], v161 offset:1024
  ds_read_b128 v[172:175], v161 offset:2048
  ds_read_b128 v[176:179], v161 offset:3072
  ds_read_b128 v[180:183], v161 offset:4096
  ds_read_b128 v[184:187], v161 offset:5120
  ds_read_b128 v[188:191], v161 offset:6144
  ds_read_b128 v[192:195], v161 offset:7168
  ds_read_b128 v[196:199], v161 offset:8192
  ds_read_b128 v[200:203], v161 offset:9216
  ds_read_b128 v[204:207], v161 offset:10240
  ds_read_b128 v[208:211], v161 offset:11264
  ds_read_b128 v[212:215], v161 offset:12288
  ds_read_b128 v[216:219], v161 offset:13312
  ds_read_b128 v[220:223], v161 offset:14336
  ds_read_b128 v[224:227], v161 offset:15360
  s_waitcnt lgkmcnt(0)
  v_add_f32 v164, v164, v196
  v_add_f32 v165, v165, v197
  v_add_f32 v166, v166, v198
  v_add_f32 v167, v167, v199
  v_add_f32 v168, v168, v200
  v_add_f32 v169, v169, v201
  v_add_f32 v170, v170, v202
  v_add_f32 v171, v171, v203
  v_add_f32 v172, v172, v204
  v_add_f32 v173, v173, v205
  v_add_f32 v174, v174, v206
  v_add_f32 v175, v175, v207
  v_add_f32 v176, v176, v208
  v_add_f32 v177, v177, v209
  v_add_f32 v178, v178, v210
  v_add_f32 v179, v179, v211
  v_add_f32 v180, v180, v212
  v_add_f32 v181, v181, v213
  v_add_f32 v182, v182, v214
  v_add_f32 v183, v183, v215
  v_add_f32 v184, v184, v216
  v_add_f32 v185, v185, v217
  v_add_f32 v186, v186, v218
  v_add_f32 v187, v187, v219
  v_add_f32 v188, v188, v220
  v_add_f32 v189, v189, v221
  v_add_f32 v190, v190, v222
  v_add_f32 v191, v191, v223
  v_add_f32 v192, v192, v224
  v_add_f32 v193, v193, v225
  v_add_f32 v194, v194, v226
  v_add_f32 v195, v195, v227
  v_add_f32 v164, v164, v180
  v_add_f32 v165, v165, v181
  v_add_f32 v166, v166, v182
  v_add_f32 v167, v167, v183
  v_add_f32 v168, v168, v184
  v_add_f32 v169, v169, v185
  v_add_f32 v170, v170, v186
  v_add_f32 v171, v171, v187
  v_add_f32 v172, v172, v188
  v_add_f32 v173, v173, v189
  v_add_f32 v174, v174, v190
  v_add_f32 v175, v175, v191
  v_add_f32 v176, v176, v192
  v_add_f32 v177, v177, v193
  v_add_f32 v178, v178, v194
  v_add_f32 v179, v179, v195
  v_add_f32 v164, v164, v172
  v_add_f32 v165, v165, v173
  v_add_f32 v166, v166, v174
  v_add_f32 v167, v167, v175
  v_add_f32 v168, v168, v176
  v_add_f32 v169, v169, v177
  v_add_f32 v170, v170, v178
  v_add_f32 v171, v171, v179
  v_add_f32 v164, v164, v168
  v_add_f32 v165, v165, v169
  v_add_f32 v166, v166, v170
  v_add_f32 v167, v167, v171
  v_cvt_pk_bf16_f32 v164, v164, v164
  v_and_b32 v164, s70, v164
  v_cvt_pk_bf16_f32 v165, v165, v165
  v_and_b32 v165, s70, v165
  v_cvt_pk_bf16_f32 v166, v166, v166
  v_and_b32 v166, s70, v166
  v_cvt_pk_bf16_f32 v167, v167, v167
  v_and_b32 v167, s70, v167
  v_add_u32 v164, 0x200, v164
  v_add_u32 v165, 0x200, v165
  v_add_u32 v166, 0x200, v166
  v_add_u32 v167, 0x200, v167
  v_lshrrev_b32 v164, 10, v164
  v_lshrrev_b32 v165, 10, v165
  v_lshrrev_b32 v166, 10, v166
  v_lshrrev_b32 v167, 10, v167
  v_lshl_or_b32 v168, v165, 22, v164
  v_lshrrev_b32 v165, 10, v165
  v_lshl_or_b32 v169, v166, 12, v165
  v_lshrrev_b32 v166, 20, v166
  v_lshl_or_b32 v170, v167, 2, v166
  v_or_b32 v170, s73, v170
  v_mov_b32 v171, s71
  s_mul_i32 s3, s40, 5
  s_add_u32 s3, s3, s41
  s_lshl_b32 s3, s3, 10
  s_add_u32 s3, s3, 4259840
  v_add_u32 v160, s3, v160
  global_store_dwordx4 v160, v[168:171], s[38:39] sc1
  s_nop 1
L_ws_15:
L_nprod_10:
  s_cmp_lt_u32 s42, 4
  s_cbranch_scc1 L_w03_18
  buffer_load_dwordx4 v[64:67], v2, s[4:7], s45 offen offset:0 nt
  buffer_load_dwordx4 v[68:71], v2, s[4:7], s45 offen offset:128 nt
  buffer_load_dwordx4 v[72:75], v2, s[4:7], s45 offen offset:256 nt
  buffer_load_dwordx4 v[76:79], v3, s[4:7], s45 offen offset:0 nt
  buffer_load_dwordx4 v[80:83], v3, s[4:7], s45 offen offset:128 nt
  buffer_load_dwordx4 v[84:87], v3, s[4:7], s45 offen offset:256 nt
  buffer_load_dwordx4 v[88:91], v4, s[4:7], s45 offen offset:0 nt
  buffer_load_dwordx4 v[92:95], v4, s[4:7], s45 offen offset:128 nt
  buffer_load_dwordx4 v[96:99], v4, s[4:7], s45 offen offset:256 nt
  buffer_load_dwordx4 v[100:103], v5, s[4:7], s45 offen offset:0 nt
  buffer_load_dwordx4 v[104:107], v5, s[4:7], s45 offen offset:128 nt
  buffer_load_dwordx4 v[108:111], v5, s[4:7], s45 offen offset:256 nt
  buffer_load_dwordx4 v[112:115], v2, s[8:11], s45 offen offset:0 nt
  buffer_load_dwordx4 v[116:119], v2, s[8:11], s45 offen offset:128 nt
  buffer_load_dwordx4 v[120:123], v2, s[8:11], s45 offen offset:256 nt
  buffer_load_dwordx4 v[124:127], v3, s[8:11], s45 offen offset:0 nt
  buffer_load_dwordx4 v[128:131], v3, s[8:11], s45 offen offset:128 nt
  buffer_load_dwordx4 v[132:135], v3, s[8:11], s45 offen offset:256 nt
  buffer_load_dwordx4 v[136:139], v4, s[8:11], s45 offen offset:0 nt
  buffer_load_dwordx4 v[140:143], v4, s[8:11], s45 offen offset:128 nt
  buffer_load_dwordx4 v[144:147], v4, s[8:11], s45 offen offset:256 nt
  buffer_load_dwordx4 v[148:151], v5, s[8:11], s45 offen offset:0 nt
  buffer_load_dwordx4 v[152:155], v5, s[8:11], s45 offen offset:128 nt
  buffer_load_dwordx4 v[156:159], v5, s[8:11], s45 offen offset:256 nt
  buffer_load_dwordx4 v[160:163], v2, s[4:7], s98 offen offset:0 nt
  buffer_load_dwordx4 v[164:167], v2, s[4:7], s98 offen offset:128 nt
  buffer_load_dwordx4 v[168:171], v2, s[4:7], s98 offen offset:256 nt
  buffer_load_dwordx4 v[172:175], v3, s[4:7], s98 offen offset:0 nt
  buffer_load_dwordx4 v[176:179], v3, s[4:7], s98 offen offset:128 nt
  buffer_load_dwordx4 v[180:183], v3, s[4:7], s98 offen offset:256 nt
  buffer_load_dwordx4 v[184:187], v4, s[4:7], s98 offen offset:0 nt
  buffer_load_dwordx4 v[188:191], v4, s[4:7], s98 offen offset:128 nt
  buffer_load_dwordx4 v[192:195], v4, s[4:7], s98 offen offset:256 nt
  buffer_load_dwordx4 v[196:199], v5, s[4:7], s98 offen offset:0 nt
  buffer_load_dwordx4 v[200:203], v5, s[4:7], s98 offen offset:128 nt
  buffer_load_dwordx4 v[204:207], v5, s[4:7], s98 offen offset:256 nt
  buffer_load_dwordx4 v[208:211], v2, s[8:11], s98 offen offset:0 nt
  buffer_load_dwordx4 v[212:215], v2, s[8:11], s98 offen offset:128 nt
  buffer_load_dwordx4 v[216:219], v2, s[8:11], s98 offen offset:256 nt
  buffer_load_dwordx4 v[220:223], v3, s[8:11], s98 offen offset:0 nt
  buffer_load_dwordx4 v[224:227], v3, s[8:11], s98 offen offset:128 nt
  buffer_load_dwordx4 v[228:231], v3, s[8:11], s98 offen offset:256 nt
  buffer_load_dwordx4 v[232:235], v4, s[8:11], s98 offen offset:0 nt
  buffer_load_dwordx4 v[236:239], v4, s[8:11], s98 offen offset:128 nt
  buffer_load_dwordx4 v[240:243], v4, s[8:11], s98 offen offset:256 nt
  buffer_load_dwordx4 v[244:247], v5, s[8:11], s98 offen offset:0 nt
  buffer_load_dwordx4 v[248:251], v5, s[8:11], s98 offen offset:128 nt
  buffer_load_dwordx4 v[252:255], v5, s[8:11], s98 offen offset:256 nt
  s_cmp_lt_u32 s42, 6
  s_cbranch_scc1 L_ws_37
  v_mov_b32 v48, 0
  v_mov_b32 v49, 0
  v_mov_b32 v50, 0
  v_mov_b32 v51, 0
  s_sub_u32 s3, s42, 6
  s_mul_i32 s3, s3, 25600
  s_add_u32 s3, s3, 22528
  v_lshlrev_b32 v52, 4, v1
  v_add_u32 v52, s3, v52
  ds_write_b128 v52, v[48:51] offset:0
  ds_write_b128 v52, v[48:51] offset:1024
  ds_write_b128 v52, v[48:51] offset:2048
  ds_write_b128 v52, v[48:51] offset:3072
  ds_write_b128 v52, v[48:51] offset:4096
  ds_write_b128 v52, v[48:51] offset:5120
  ds_write_b128 v52, v[48:51] offset:6144
  ds_write_b128 v52, v[48:51] offset:7168
  ds_write_b128 v52, v[48:51] offset:8192
  ds_write_b128 v52, v[48:51] offset:9216
  ds_write_b128 v52, v[48:51] offset:10240
  ds_write_b128 v52, v[48:51] offset:11264
  ds_write_b128 v52, v[48:51] offset:12288
  ds_write_b128 v52, v[48:51] offset:13312
  ds_write_b128 v52, v[48:51] offset:14336
  ds_write_b128 v52, v[48:51] offset:15360
  ds_write_b128 v52, v[48:51] offset:16384
  ds_write_b128 v52, v[48:51] offset:17408
  ds_write_b128 v52, v[48:51] offset:18432
  ds_write_b128 v52, v[48:51] offset:19456
  ds_write_b128 v52, v[48:51] offset:20480
  ds_write_b128 v52, v[48:51] offset:21504
  ds_write_b128 v52, v[48:51] offset:22528
  ds_write_b128 v52, v[48:51] offset:23552
  ds_write_b128 v52, v[48:51] offset:24576
  s_waitcnt lgkmcnt(0)
  v_mul_u32_u24 v52, 1600, v1
  v_add_u32 v52, s3, v52
  v_mov_b32 v48, 0xf149f2ca
  s_mov_b64 exec, 0xffff
  ds_write_b32 v52, v48 offset:1536
  s_mov_b64 exec, -1
  s_waitcnt lgkmcnt(0)
  v_mov_b32 v44, 13192
  v_mov_b32 v45, 1
  s_mov_b64 exec, 1
  ds_add_u32 v44, v45
  s_mov_b64 exec, -1
L_ws_37:
  s_waitcnt vmcnt(48)
  v_readfirstlane_b32 s71, v15
  s_add_u32 s71, s71, 1
  s_mul_i32 s73, s71, 0x9e3779b1
  s_and_b32 s73, s73, 0xff000000
  v_mov_b32 v46, 13192
  s_nop 1
  s_branch L_spin_19
L_w03_18:
  s_waitcnt vmcnt(0)
  v_readfirstlane_b32 s71, v15
  s_add_u32 s71, s71, 1
  s_mul_i32 s73, s71, 0x9e3779b1
  s_and_b32 s73, s73, 0xff000000
  s_cmp_eq_u32 s42, 3
  s_nop 0
  s_cbranch_scc1 L_w3_38
  s_mul_i32 s3, s40, 5
  s_add_u32 s3, s3, s42
  s_lshl_b32 s3, s3, 10
  s_add_u32 s3, s3, 4259840
  v_lshlrev_b32 v160, 4, v1
  v_add_u32 v160, s3, v160
  s_mov_b64 s[54:55], exec
  s_mov_b32 s3, 0x40000
L_gpoll_40:
  global_load_dwordx4 v[164:167], v160, s[38:39] offset:0 sc1
  s_waitcnt vmcnt(0)
  v_xor_b32 v254, s73, v166
  v_and_b32 v254, s74, v254
  v_xor_b32 v255, s71, v167
  v_or_b32 v255, v255, v254
  v_cmp_ne_u32 vcc, 0, v255
  s_and_b64 exec, exec, vcc
  s_nop 3
  s_cbranch_execz L_gdone_41
  s_sub_u32 s3, s3, 1
  s_cbranch_scc0 L_gpoll_40
L_gdone_41:
  s_mov_b64 exec, s[54:55]
  v_lshlrev_b32 v167, 8, v166
  v_alignbit_b32 v166, v166, v165, 2
  v_alignbit_b32 v165, v165, v164, 12
  v_lshlrev_b32 v164, 10, v164
  v_and_b32 v165, s72, v165
  v_and_b32 v166, s72, v166
  v_and_b32 v167, s72, v167
  v_cvt_pk_bf16_f32 v162, v164, v165
  v_cvt_pk_bf16_f32 v163, v166, v167
  v_lshrrev_b32 v160, 4, v1
  v_mul_u32_u24 v160, 384, v160
  v_and_b32 v161, 15, v1
  v_lshlrev_b32 v161, 3, v161
  v_add_u32 v160, v160, v161
  s_lshl_b32 s3, s42, 7
  v_add_u32 v160, s3, v160
  ds_write_b64 v160, v[162:163] offset:10240
  s_waitcnt lgkmcnt(0)
  v_mov_b32 v44, 13192
  v_mov_b32 v45, 1
  s_mov_b64 exec, 1
  ds_add_u32 v44, v45
  s_mov_b64 exec, -1
  s_branch L_gj_39
L_w3_38:
  s_cmp_ge_u32 s40, 24
  s_cbranch_scc1 L_gj_39
  s_mul_i32 s3, s40, 5
  s_add_u32 s3, s3, 3
  s_lshl_b32 s3, s3, 10
  s_add_u32 s3, s3, 4259840
  v_lshlrev_b32 v160, 4, v1
  v_add_u32 v160, s3, v160
  s_mov_b64 s[54:55], exec
  s_mov_b32 s3, 0x40000
L_gpoll_42:
  global_load_dwordx4 v[164:167], v160, s[38:39] offset:0 sc1
  global_load_dwordx4 v[168:171], v160, s[38:39] offset:1024 sc1
  s_waitcnt vmcnt(0)
  v_xor_b32 v254, s73, v166
  v_and_b32 v254, s74, v254
  v_xor_b32 v255, s71, v167
  v_or_b32 v255, v255, v254
  v_xor_b32 v254, s73, v170
  v_and_b32 v254, s74, v254
  v_or_b32 v255, v255, v254
  v_xor_b32 v254, s71, v171
  v_or_b32 v255, v255, v254
  v_cmp_ne_u32 vcc, 0, v255
  s_and_b64 exec, exec, vcc
  s_nop 3
  s_cbranch_execz L_gdone_43
  s_sub_u32 s3, s3, 1
  s_cbranch_scc0 L_gpoll_42
L_gdone_43:
  s_mov_b64 exec, s[54:55]
  v_lshlrev_b32 v167, 8, v166
  v_alignbit_b32 v166, v166, v165, 2
  v_alignbit_b32 v165, v165, v164, 12
  v_lshlrev_b32 v164, 10, v164
  v_and_b32 v165, s72, v165
  v_and_b32 v166, s72, v166
  v_and_b32 v167, s72, v167
  v_lshlrev_b32 v171, 8, v170
  v_alignbit_b32 v170, v170, v169, 2
  v_alignbit_b32 v169, v169, v168, 12
  v_lshlrev_b32 v168, 10, v168
  v_and_b32 v169, s72, v169
  v_and_b32 v170, s72, v170
  v_and_b32 v171, s72, v171
  v_mul_f32 v172, v164, v164
  v_mul_f32 v172, v172, v164
  v_mov_b32 v173, 0x3d372713
  v_fma_f32 v172, v172, v173, v164
  v_mul_f32 v172, 0x40135761, v172
  v_exp_f32 v172, v172
  s_nop 0
  v_add_f32 v172, 1.0, v172
  v_rcp_f32 v172, v172
  s_nop 0
  v_fma_f32 v172, v172, -2.0, 1.0
  v_add_f32 v172, 1.0, v172
  v_mul_f32 v173, 0.5, v164
  v_mul_f32 v172, v172, v173
  v_cvt_pk_bf16_f32 v172, v172, v172
  v_and_b32 v172, s70, v172
  v_mul_f32 v172, v172, v168
  v_cvt_pk_bf16_f32 v176, v172, v172
  v_mul_f32 v172, v165, v165
  v_mul_f32 v172, v172, v165
  v_mov_b32 v173, 0x3d372713
  v_fma_f32 v172, v172, v173, v165
  v_mul_f32 v172, 0x40135761, v172
  v_exp_f32 v172, v172
  s_nop 0
  v_add_f32 v172, 1.0, v172
  v_rcp_f32 v172, v172
  s_nop 0
  v_fma_f32 v172, v172, -2.0, 1.0
  v_add_f32 v172, 1.0, v172
  v_mul_f32 v173, 0.5, v165
  v_mul_f32 v172, v172, v173
  v_cvt_pk_bf16_f32 v172, v172, v172
  v_and_b32 v172, s70, v172
  v_mul_f32 v172, v172, v169
  v_cvt_pk_bf16_f32 v177, v172, v172
  v_mul_f32 v172, v166, v166
  v_mul_f32 v172, v172, v166
  v_mov_b32 v173, 0x3d372713
  v_fma_f32 v172, v172, v173, v166
  v_mul_f32 v172, 0x40135761, v172
  v_exp_f32 v172, v172
  s_nop 0
  v_add_f32 v172, 1.0, v172
  v_rcp_f32 v172, v172
  s_nop 0
  v_fma_f32 v172, v172, -2.0, 1.0
  v_add_f32 v172, 1.0, v172
  v_mul_f32 v173, 0.5, v166
  v_mul_f32 v172, v172, v173
  v_cvt_pk_bf16_f32 v172, v172, v172
  v_and_b32 v172, s70, v172
  v_mul_f32 v172, v172, v170
  v_cvt_pk_bf16_f32 v178, v172, v172
  v_mul_f32 v172, v167, v167
  v_mul_f32 v172, v172, v167
  v_mov_b32 v173, 0x3d372713
  v_fma_f32 v172, v172, v173, v167
  v_mul_f32 v172, 0x40135761, v172
  v_exp_f32 v172, v172
  s_nop 0
  v_add_f32 v172, 1.0, v172
  v_rcp_f32 v172, v172
  s_nop 0
  v_fma_f32 v172, v172, -2.0, 1.0
  v_add_f32 v172, 1.0, v172
  v_mul_f32 v173, 0.5, v167
  v_mul_f32 v172, v172, v173
  v_cvt_pk_bf16_f32 v172, v172, v172
  v_and_b32 v172, s70, v172
  v_mul_f32 v172, v172, v171
  v_cvt_pk_bf16_f32 v179, v172, v172
  v_lshlrev_b32 v160, 4, v1
  ds_write_b128 v160, v[176:179] offset:11776
  s_nop 0
L_gj_39:
  buffer_load_dwordx4 v[64:67], v2, s[4:7], s45 offen offset:0 nt
  buffer_load_dwordx4 v[68:71], v2, s[4:7], s45 offen offset:128 nt
  buffer_load_dwordx4 v[72:75], v2, s[4:7], s45 offen offset:256 nt
  buffer_load_dwordx4 v[76:79], v3, s[4:7], s45 offen offset:0 nt
  buffer_load_dwordx4 v[80:83], v3, s[4:7], s45 offen offset:128 nt
  buffer_load_dwordx4 v[84:87], v3, s[4:7], s45 offen offset:256 nt
  buffer_load_dwordx4 v[88:91], v4, s[4:7], s45 offen offset:0 nt
  buffer_load_dwordx4 v[92:95], v4, s[4:7], s45 offen offset:128 nt
  buffer_load_dwordx4 v[96:99], v4, s[4:7], s45 offen offset:256 nt
  buffer_load_dwordx4 v[100:103], v5, s[4:7], s45 offen offset:0 nt
  buffer_load_dwordx4 v[104:107], v5, s[4:7], s45 offen offset:128 nt
  buffer_load_dwordx4 v[108:111], v5, s[4:7], s45 offen offset:256 nt
  buffer_load_dwordx4 v[112:115], v2, s[8:11], s45 offen offset:0 nt
  buffer_load_dwordx4 v[116:119], v2, s[8:11], s45 offen offset:128 nt
  buffer_load_dwordx4 v[120:123], v2, s[8:11], s45 offen offset:256 nt
  buffer_load_dwordx4 v[124:127], v3, s[8:11], s45 offen offset:0 nt
  buffer_load_dwordx4 v[128:131], v3, s[8:11], s45 offen offset:128 nt
  buffer_load_dwordx4 v[132:135], v3, s[8:11], s45 offen offset:256 nt
  buffer_load_dwordx4 v[136:139], v4, s[8:11], s45 offen offset:0 nt
  buffer_load_dwordx4 v[140:143], v4, s[8:11], s45 offen offset:128 nt
  buffer_load_dwordx4 v[144:147], v4, s[8:11], s45 offen offset:256 nt
  buffer_load_dwordx4 v[148:151], v5, s[8:11], s45 offen offset:0 nt
  buffer_load_dwordx4 v[152:155], v5, s[8:11], s45 offen offset:128 nt
  buffer_load_dwordx4 v[156:159], v5, s[8:11], s45 offen offset:256 nt
  buffer_load_dwordx4 v[160:163], v2, s[4:7], s98 offen offset:0 nt
  buffer_load_dwordx4 v[164:167], v2, s[4:7], s98 offen offset:128 nt
  buffer_load_dwordx4 v[168:171], v2, s[4:7], s98 offen offset:256 nt
  buffer_load_dwordx4 v[172:175], v3, s[4:7], s98 offen offset:0 nt
  buffer_load_dwordx4 v[176:179], v3, s[4:7], s98 offen offset:128 nt
  buffer_load_dwordx4 v[180:183], v3, s[4:7], s98 offen offset:256 nt
  buffer_load_dwordx4 v[184:187], v4, s[4:7], s98 offen offset:0 nt
  buffer_load_dwordx4 v[188:191], v4, s[4:7], s98 offen offset:128 nt
  buffer_load_dwordx4 v[192:195], v4, s[4:7], s98 offen offset:256 nt
  buffer_load_dwordx4 v[196:199], v5, s[4:7], s98 offen offset:0 nt
  buffer_load_dwordx4 v[200:203], v5, s[4:7], s98 offen offset:128 nt
  buffer_load_dwordx4 v[204:207], v5, s[4:7], s98 offen offset:256 nt
  buffer_load_dwordx4 v[208:211], v2, s[8:11], s98 offen offset:0 nt
  buffer_load_dwordx4 v[212:215], v2, s[8:11], s98 offen offset:128 nt
  buffer_load_dwordx4 v[216:219], v2, s[8:11], s98 offen offset:256 nt
  buffer_load_dwordx4 v[220:223], v3, s[8:11], s98 offen offset:0 nt
  buffer_load_dwordx4 v[224:227], v3, s[8:11], s98 offen offset:128 nt
  buffer_load_dwordx4 v[228:231], v3, s[8:11], s98 offen offset:256 nt
  buffer_load_dwordx4 v[232:235], v4, s[8:11], s98 offen offset:0 nt
  buffer_load_dwordx4 v[236:239], v4, s[8:11], s98 offen offset:128 nt
  buffer_load_dwordx4 v[240:243], v4, s[8:11], s98 offen offset:256 nt
  buffer_load_dwordx4 v[244:247], v5, s[8:11], s98 offen offset:0 nt
  buffer_load_dwordx4 v[248:251], v5, s[8:11], s98 offen offset:128 nt
  buffer_load_dwordx4 v[252:255], v5, s[8:11], s98 offen offset:256 nt
L_spin_19:
  v_mov_b32 v44, 13192
  s_mov_b32 s58, 0x400000
  s_nop 0
L_lw_44:
  ds_read_b32 v45, v44
  s_waitcnt lgkmcnt(0)
  v_readfirstlane_b32 s3, v45
  s_cmp_eq_u32 s3, 5
  s_nop 3
  s_cbranch_scc1 L_lwd_45
  s_sub_u32 s58, s58, 1
  s_cbranch_scc0 L_lw_44
L_lwd_45:
  v_mov_b32 v28, 0
  v_mov_b32 v29, 0
  v_mov_b32 v30, 0
  v_mov_b32 v31, 0
  v_mov_b32 v32, 0
  v_mov_b32 v33, 0
  v_mov_b32 v34, 0
  v_mov_b32 v35, 0
  v_mov_b32 v36, 0
  v_mov_b32 v37, 0
  v_mov_b32 v38, 0
  v_mov_b32 v39, 0
  v_mov_b32 v15, 0
  v_mov_b32 v13, 0xf149f2ca
  v_mov_b32 v14, 0xf149f2ca
  s_mov_b32 s64, 0
  s_mov_b32 s65, 0
  s_mov_b32 s48, s47
  s_mul_i32 s58, s48, 384
  v_and_b32 v44, 7, v1
  v_lshlrev_b32 v44, 4, v44
  v_add_u32 v44, s58, v44
  ds_read_b128 v[16:19], v44 offset:10240
  ds_read_b128 v[20:23], v44 offset:10368
  ds_read_b128 v[24:27], v44 offset:10496
  s_waitcnt lgkmcnt(0)
  s_waitcnt vmcnt(45)
  v_dot2_f32_bf16 v40, v64, v16, 0
  v_dot2_f32_bf16 v40, v65, v17, v40
  v_dot2_f32_bf16 v40, v66, v18, v40
  v_dot2_f32_bf16 v40, v67, v19, v40
  v_dot2_f32_bf16 v40, v68, v20, v40
  v_dot2_f32_bf16 v40, v69, v21, v40
  v_dot2_f32_bf16 v40, v70, v22, v40
  v_dot2_f32_bf16 v40, v71, v23, v40
  v_dot2_f32_bf16 v40, v72, v24, v40
  v_dot2_f32_bf16 v40, v73, v25, v40
  v_dot2_f32_bf16 v40, v74, v26, v40
  v_dot2_f32_bf16 v40, v75, v27, v40
  s_waitcnt vmcnt(42)
  v_dot2_f32_bf16 v41, v76, v16, 0
  v_dot2_f32_bf16 v41, v77, v17, v41
  v_dot2_f32_bf16 v41, v78, v18, v41
  v_dot2_f32_bf16 v41, v79, v19, v41
  v_dot2_f32_bf16 v41, v80, v20, v41
  v_dot2_f32_bf16 v41, v81, v21, v41
  v_dot2_f32_bf16 v41, v82, v22, v41
  v_dot2_f32_bf16 v41, v83, v23, v41
  v_dot2_f32_bf16 v41, v84, v24, v41
  v_dot2_f32_bf16 v41, v85, v25, v41
  v_dot2_f32_bf16 v41, v86, v26, v41
  v_dot2_f32_bf16 v41, v87, v27, v41
  s_waitcnt vmcnt(39)
  v_dot2_f32_bf16 v42, v88, v16, 0
  v_dot2_f32_bf16 v42, v89, v17, v42
  v_dot2_f32_bf16 v42, v90, v18, v42
  v_dot2_f32_bf16 v42, v91, v19, v42
  v_dot2_f32_bf16 v42, v92, v20, v42
  v_dot2_f32_bf16 v42, v93, v21, v42
  v_dot2_f32_bf16 v42, v94, v22, v42
  v_dot2_f32_bf16 v42, v95, v23, v42
  v_dot2_f32_bf16 v42, v96, v24, v42
  v_dot2_f32_bf16 v42, v97, v25, v42
  v_dot2_f32_bf16 v42, v98, v26, v42
  v_dot2_f32_bf16 v42, v99, v27, v42
  s_waitcnt vmcnt(36)
  v_dot2_f32_bf16 v43, v100, v16, 0
  v_dot2_f32_bf16 v43, v101, v17, v43
  v_dot2_f32_bf16 v43, v102, v18, v43
  v_dot2_f32_bf16 v43, v103, v19, v43
  v_dot2_f32_bf16 v43, v104, v20, v43
  v_dot2_f32_bf16 v43, v105, v21, v43
  v_dot2_f32_bf16 v43, v106, v22, v43
  v_dot2_f32_bf16 v43, v107, v23, v43
  v_dot2_f32_bf16 v43, v108, v24, v43
  v_dot2_f32_bf16 v43, v109, v25, v43
  v_dot2_f32_bf16 v43, v110, v26, v43
  v_dot2_f32_bf16 v43, v111, v27, v43
  v_add_f32_dpp v40, v40, v40 quad_perm:[1,0,3,2] row_mask:0xf bank_mask:0xf
  v_add_f32_dpp v41, v41, v41 quad_perm:[1,0,3,2] row_mask:0xf bank_mask:0xf
  v_add_f32_dpp v42, v42, v42 quad_perm:[1,0,3,2] row_mask:0xf bank_mask:0xf
  v_add_f32_dpp v43, v43, v43 quad_perm:[1,0,3,2] row_mask:0xf bank_mask:0xf
  v_add_f32_dpp v40, v40, v40 quad_perm:[2,3,0,1] row_mask:0xf bank_mask:0xf
  v_add_f32_dpp v41, v41, v41 quad_perm:[2,3,0,1] row_mask:0xf bank_mask:0xf
  v_add_f32_dpp v42, v42, v42 quad_perm:[2,3,0,1] row_mask:0xf bank_mask:0xf
  v_add_f32_dpp v43, v43, v43 quad_perm:[2,3,0,1] row_mask:0xf bank_mask:0xf
  v_add_f32_dpp v40, v40, v40 row_half_mirror row_mask:0xf bank_mask:0xf
  v_add_f32_dpp v41, v41, v41 row_half_mirror row_mask:0xf bank_mask:0xf
  v_add_f32_dpp v42, v42, v42 row_half_mirror row_mask:0xf bank_mask:0xf
  v_add_f32_dpp v43, v43, v43 row_half_mirror row_mask:0xf bank_mask:0xf
  v_cvt_pk_bf16_f32 v44, v40, v41
  v_cvt_pk_bf16_f32 v45, v42, v43
  v_lshlrev_b32 v40, 16, v44
  v_and_b32 v41, s70, v44
  v_lshlrev_b32 v42, 16, v45
  v_and_b32 v43, s70, v45
  v_mul_f32 v40, s66, v40
  v_mul_f32 v41, s66, v41
  v_mul_f32 v42, s66, v42
  v_mul_f32 v43, s66, v43
  v_cvt_pk_bf16_f32 v44, v40, v41
  v_cvt_pk_bf16_f32 v45, v42, v43
  v_lshlrev_b32 v40, 16, v44
  v_and_b32 v41, s70, v44
  v_lshlrev_b32 v42, 16, v45
  v_and_b32 v43, s70, v45
  v_max3_f32 v44, v40, v41, v42
  v_max_f32 v44, v44, v43
  v_cmp_gt_f32 vcc, v44, v13
  s_nop 4
  s_cbranch_vccz L_nomax_48
  v_max_f32_dpp v44, v44, v44 row_ror:8 row_mask:0xf bank_mask:0xf
  s_nop 0
  v_readlane_b32 s58, v44, 0
  v_readlane_b32 s59, v44, 16
  v_readlane_b32 s60, v44, 32
  v_readlane_b32 s61, v44, 48
  v_mov_b32 v44, s58
  v_max_f32 v44, s59, v44
  v_max_f32 v44, s60, v44
  v_max_f32 v44, s61, v44
  v_max_f32 v13, v13, v44
  v_mul_f32 v45, s67, v13
  v_sub_f32 v46, v14, v45
  v_exp_f32 v46, v46
  v_mov_b32 v14, v45
  v_mul_f32 v28, v28, v46
  v_mul_f32 v29, v29, v46
  v_mul_f32 v30, v30, v46
  v_mul_f32 v31, v31, v46
  v_mul_f32 v32, v32, v46
  v_mul_f32 v33, v33, v46
  v_mul_f32 v34, v34, v46
  v_mul_f32 v35, v35, v46
  v_mul_f32 v36, v36, v46
  v_mul_f32 v37, v37, v46
  v_mul_f32 v38, v38, v46
  v_mul_f32 v39, v39, v46
  v_mul_f32 v15, v15, v46
  s_nop 1
L_nomax_48:
  v_fma_f32 v40, v40, s67, -v14
  v_fma_f32 v41, v41, s67, -v14
  v_fma_f32 v42, v42, s67, -v14
  v_fma_f32 v43, v43, s67, -v14
  v_exp_f32 v40, v40
  v_exp_f32 v41, v41
  v_exp_f32 v42, v42
  v_exp_f32 v43, v43
  v_add_f32 v15, v15, v40
  v_cvt_pk_bf16_f32 v44, v40, v40
  v_add_f32 v15, v15, v41
  v_cvt_pk_bf16_f32 v45, v41, v41
  v_add_f32 v15, v15, v42
  v_cvt_pk_bf16_f32 v46, v42, v42
  v_add_f32 v15, v15, v43
  v_cvt_pk_bf16_f32 v47, v43, v43
  v_and_b32 v48, v44, v9
  v_and_b32 v49, v44, v10
  v_and_b32 v50, v44, v11
  v_and_b32 v51, v44, v12
  v_and_b32 v52, v45, v9
  v_and_b32 v53, v45, v10
  v_and_b32 v54, v45, v11
  v_and_b32 v55, v45, v12
  v_and_b32 v56, v46, v9
  v_and_b32 v57, v46, v10
  v_and_b32 v58, v46, v11
  v_and_b32 v59, v46, v12
  v_and_b32 v60, v47, v9
  v_and_b32 v61, v47, v10
  v_and_b32 v62, v47, v11
  v_and_b32 v63, v47, v12
  s_waitcnt vmcnt(33)
  v_mfma_f32_16x16x32_bf16 v[28:31], v[48:51], v[112:115], v[28:31]
  v_mfma_f32_16x16x32_bf16 v[32:35], v[48:51], v[116:119], v[32:35]
  v_mfma_f32_16x16x32_bf16 v[36:39], v[48:51], v[120:123], v[36:39]
  s_waitcnt vmcnt(30)
  v_mfma_f32_16x16x32_bf16 v[28:31], v[52:55], v[124:127], v[28:31]
  v_mfma_f32_16x16x32_bf16 v[32:35], v[52:55], v[128:131], v[32:35]
  v_mfma_f32_16x16x32_bf16 v[36:39], v[52:55], v[132:135], v[36:39]
  s_waitcnt vmcnt(27)
  v_mfma_f32_16x16x32_bf16 v[28:31], v[56:59], v[136:139], v[28:31]
  v_mfma_f32_16x16x32_bf16 v[32:35], v[56:59], v[140:143], v[32:35]
  v_mfma_f32_16x16x32_bf16 v[36:39], v[56:59], v[144:147], v[36:39]
  s_waitcnt vmcnt(24)
  v_mfma_f32_16x16x32_bf16 v[28:31], v[60:63], v[148:151], v[28:31]
  v_mfma_f32_16x16x32_bf16 v[32:35], v[60:63], v[152:155], v[32:35]
  v_mfma_f32_16x16x32_bf16 v[36:39], v[60:63], v[156:159], v[36:39]
  s_cmp_eq_u32 s44, 0
  s_nop 6
  s_cbranch_scc0 L_have_49
  v_readfirstlane_b32 s60, v8
  s_add_u32 s60, s60, 64
  s_mov_b32 s44, 1
  s_sub_u32 s43, s60, 304
  s_add_u32 s43, s43, 3584
  s_sub_u32 s58, s60, 240
  s_mul_i32 s58, s58, 4
  s_add_u32 s58, s58, 3328
  s_cmp_lt_u32 s60, 304
  s_cselect_b32 s43, s58, s43
  s_cselect_b32 s44, 4, s44
  s_sub_u32 s58, s60, 176
  s_mul_i32 s58, s58, 8
  s_add_u32 s58, s58, 2816
  s_cmp_lt_u32 s60, 240
  s_cselect_b32 s43, s58, s43
  s_cselect_b32 s44, 8, s44
  s_sub_u32 s58, s60, 0
  s_mul_i32 s58, s58, 16
  s_add_u32 s58, s58, 0
  s_cmp_lt_u32 s60, 176
  s_cselect_b32 s43, s58, s43
  s_cselect_b32 s44, 16, s44
L_have_49:
  s_lshr_b32 s49, s43, 10
  s_mul_i32 s58, s49, 100663296
  s_and_b32 s59, s43, 1023
  s_mul_i32 s59, s59, 3072
  s_add_u32 s45, s58, s59
  s_add_u32 s45, s45, s50
  s_cmp_lt_u32 s43, 4096
  s_cselect_b32 s6, 402653184, 0
  s_cselect_b32 s10, 402653184, 0
  s_cselect_b32 s46, 1, 0
  s_cbranch_scc0 L_dummy_52
  s_add_u32 s43, s43, 1
  s_sub_u32 s44, s44, 1
  s_cmp_eq_u32 s44, 0
  s_cbranch_scc1 L_claim_50
L_dummy_52:
  buffer_load_dword v8, v6, s[12:15], 0 offen
  s_branch L_claimed_51
L_claim_50:
  s_mov_b64 exec, 1
  global_atomic_add v8, v6, v7, s[52:53] sc0
  s_mov_b64 exec, -1
L_claimed_51:
  buffer_load_dwordx4 v[64:67], v2, s[4:7], s45 offen offset:0 nt
  buffer_load_dwordx4 v[68:71], v2, s[4:7], s45 offen offset:128 nt
  buffer_load_dwordx4 v[72:75], v2, s[4:7], s45 offen offset:256 nt
  buffer_load_dwordx4 v[76:79], v2, s[8:11], s45 offen offset:0 nt
  buffer_load_dwordx4 v[80:83], v2, s[8:11], s45 offen offset:128 nt
  buffer_load_dwordx4 v[84:87], v2, s[8:11], s45 offen offset:256 nt
  s_waitcnt vmcnt(28)
  v_dot2_f32_bf16 v40, v160, v16, 0
  v_dot2_f32_bf16 v40, v161, v17, v40
  v_dot2_f32_bf16 v40, v162, v18, v40
  v_dot2_f32_bf16 v40, v163, v19, v40
  v_dot2_f32_bf16 v40, v164, v20, v40
  v_dot2_f32_bf16 v40, v165, v21, v40
  v_dot2_f32_bf16 v40, v166, v22, v40
  v_dot2_f32_bf16 v40, v167, v23, v40
  v_dot2_f32_bf16 v40, v168, v24, v40
  v_dot2_f32_bf16 v40, v169, v25, v40
  v_dot2_f32_bf16 v40, v170, v26, v40
  v_dot2_f32_bf16 v40, v171, v27, v40
  s_waitcnt vmcnt(25)
  v_dot2_f32_bf16 v41, v172, v16, 0
  v_dot2_f32_bf16 v41, v173, v17, v41
  v_dot2_f32_bf16 v41, v174, v18, v41
  v_dot2_f32_bf16 v41, v175, v19, v41
  v_dot2_f32_bf16 v41, v176, v20, v41
  v_dot2_f32_bf16 v41, v177, v21, v41
  v_dot2_f32_bf16 v41, v178, v22, v41
  v_dot2_f32_bf16 v41, v179, v23, v41
  v_dot2_f32_bf16 v41, v180, v24, v41
  v_dot2_f32_bf16 v41, v181, v25, v41
  v_dot2_f32_bf16 v41, v182, v26, v41
  v_dot2_f32_bf16 v41, v183, v27, v41
  s_waitcnt vmcnt(22)
  v_dot2_f32_bf16 v42, v184, v16, 0
  v_dot2_f32_bf16 v42, v185, v17, v42
  v_dot2_f32_bf16 v42, v186, v18, v42
  v_dot2_f32_bf16 v42, v187, v19, v42
  v_dot2_f32_bf16 v42, v188, v20, v42
  v_dot2_f32_bf16 v42, v189, v21, v42
  v_dot2_f32_bf16 v42, v190, v22, v42
  v_dot2_f32_bf16 v42, v191, v23, v42
  v_dot2_f32_bf16 v42, v192, v24, v42
  v_dot2_f32_bf16 v42, v193, v25, v42
  v_dot2_f32_bf16 v42, v194, v26, v42
  v_dot2_f32_bf16 v42, v195, v27, v42
  s_waitcnt vmcnt(19)
  v_dot2_f32_bf16 v43, v196, v16, 0
  v_dot2_f32_bf16 v43, v197, v17, v43
  v_dot2_f32_bf16 v43, v198, v18, v43
  v_dot2_f32_bf16 v43, v199, v19, v43
  v_dot2_f32_bf16 v43, v200, v20, v43
  v_dot2_f32_bf16 v43, v201, v21, v43
  v_dot2_f32_bf16 v43, v202, v22, v43
  v_dot2_f32_bf16 v43, v203, v23, v43
  v_dot2_f32_bf16 v43, v204, v24, v43
  v_dot2_f32_bf16 v43, v205, v25, v43
  v_dot2_f32_bf16 v43, v206, v26, v43
  v_dot2_f32_bf16 v43, v207, v27, v43
  v_add_f32_dpp v40, v40, v40 quad_perm:[1,0,3,2] row_mask:0xf bank_mask:0xf
  v_add_f32_dpp v41, v41, v41 quad_perm:[1,0,3,2] row_mask:0xf bank_mask:0xf
  v_add_f32_dpp v42, v42, v42 quad_perm:[1,0,3,2] row_mask:0xf bank_mask:0xf
  v_add_f32_dpp v43, v43, v43 quad_perm:[1,0,3,2] row_mask:0xf bank_mask:0xf
  v_add_f32_dpp v40, v40, v40 quad_perm:[2,3,0,1] row_mask:0xf bank_mask:0xf
  v_add_f32_dpp v41, v41, v41 quad_perm:[2,3,0,1] row_mask:0xf bank_mask:0xf
  v_add_f32_dpp v42, v42, v42 quad_perm:[2,3,0,1] row_mask:0xf bank_mask:0xf
  v_add_f32_dpp v43, v43, v43 quad_perm:[2,3,0,1] row_mask:0xf bank_mask:0xf
  v_add_f32_dpp v40, v40, v40 row_half_mirror row_mask:0xf bank_mask:0xf
  v_add_f32_dpp v41, v41, v41 row_half_mirror row_mask:0xf bank_mask:0xf
  v_add_f32_dpp v42, v42, v42 row_half_mirror row_mask:0xf bank_mask:0xf
  v_add_f32_dpp v43, v43, v43 row_half_mirror row_mask:0xf bank_mask:0xf
  v_cvt_pk_bf16_f32 v44, v40, v41
  v_cvt_pk_bf16_f32 v45, v42, v43
  v_lshlrev_b32 v40, 16, v44
  v_and_b32 v41, s70, v44
  v_lshlrev_b32 v42, 16, v45
  v_and_b32 v43, s70, v45
  v_mul_f32 v40, s66, v40
  v_mul_f32 v41, s66, v41
  v_mul_f32 v42, s66, v42
  v_mul_f32 v43, s66, v43
  v_cvt_pk_bf16_f32 v44, v40, v41
  v_cvt_pk_bf16_f32 v45, v42, v43
  v_lshlrev_b32 v40, 16, v44
  v_and_b32 v41, s70, v44
  v_lshlrev_b32 v42, 16, v45
  v_and_b32 v43, s70, v45
  v_max3_f32 v44, v40, v41, v42
  v_max_f32 v44, v44, v43
  v_cmp_gt_f32 vcc, v44, v13
  s_nop 4
  s_cbranch_vccz L_nomax_53
  v_max_f32_dpp v44, v44, v44 row_ror:8 row_mask:0xf bank_mask:0xf
  s_nop 0
  v_readlane_b32 s58, v44, 0
  v_readlane_b32 s59, v44, 16
  v_readlane_b32 s60, v44, 32
  v_readlane_b32 s61, v44, 48
  v_mov_b32 v44, s58
  v_max_f32 v44, s59, v44
  v_max_f32 v44, s60, v44
  v_max_f32 v44, s61, v44
  v_max_f32 v13, v13, v44
  v_mul_f32 v45, s67, v13
  v_sub_f32 v46, v14, v45
  v_exp_f32 v46, v46
  v_mov_b32 v14, v45
  v_mul_f32 v28, v28, v46
  v_mul_f32 v29, v29, v46
  v_mul_f32 v30, v30, v46
  v_mul_f32 v31, v31, v46
  v_mul_f32 v32, v32, v46
  v_mul_f32 v33, v33, v46
  v_mul_f32 v34, v34, v46
  v_mul_f32 v35, v35, v46
  v_mul_f32 v36, v36, v46
  v_mul_f32 v37, v37, v46
  v_mul_f32 v38, v38, v46
  v_mul_f32 v39, v39, v46
  v_mul_f32 v15, v15, v46
  s_nop 1
L_nomax_53:
  v_fma_f32 v40, v40, s67, -v14
  v_fma_f32 v41, v41, s67, -v14
  v_fma_f32 v42, v42, s67, -v14
  v_fma_f32 v43, v43, s67, -v14
  v_exp_f32 v40, v40
  v_exp_f32 v41, v41
  v_exp_f32 v42, v42
  v_exp_f32 v43, v43
  v_add_f32 v15, v15, v40
  v_cvt_pk_bf16_f32 v44, v40, v40
  v_add_f32 v15, v15, v41
  v_cvt_pk_bf16_f32 v45, v41, v41
  v_add_f32 v15, v15, v42
  v_cvt_pk_bf16_f32 v46, v42, v42
  v_add_f32 v15, v15, v43
  v_cvt_pk_bf16_f32 v47, v43, v43
  v_and_b32 v48, v44, v9
  v_and_b32 v49, v44, v10
  v_and_b32 v50, v44, v11
  v_and_b32 v51, v44, v12
  v_and_b32 v52, v45, v9
  v_and_b32 v53, v45, v10
  v_and_b32 v54, v45, v11
  v_and_b32 v55, v45, v12
  v_and_b32 v56, v46, v9
  v_and_b32 v57, v46, v10
  v_and_b32 v58, v46, v11
  v_and_b32 v59, v46, v12
  v_and_b32 v60, v47, v9
  v_and_b32 v61, v47, v10
  v_and_b32 v62, v47, v11
  v_and_b32 v63, v47, v12
  s_waitcnt vmcnt(16)
  v_mfma_f32_16x16x32_bf16 v[28:31], v[48:51], v[208:211], v[28:31]
  v_mfma_f32_16x16x32_bf16 v[32:35], v[48:51], v[212:215], v[32:35]
  v_mfma_f32_16x16x32_bf16 v[36:39], v[48:51], v[216:219], v[36:39]
  s_waitcnt vmcnt(13)
  v_mfma_f32_16x16x32_bf16 v[28:31], v[52:55], v[220:223], v[28:31]
  v_mfma_f32_16x16x32_bf16 v[32:35], v[52:55], v[224:227], v[32:35]
  v_mfma_f32_16x16x32_bf16 v[36:39], v[52:55], v[228:231], v[36:39]
  s_waitcnt vmcnt(10)
  v_mfma_f32_16x16x32_bf16 v[28:31], v[56:59], v[232:235], v[28:31]
  v_mfma_f32_16x16x32_bf16 v[32:35], v[56:59], v[236:239], v[32:35]
  v_mfma_f32_16x16x32_bf16 v[36:39], v[56:59], v[240:243], v[36:39]
  s_waitcnt vmcnt(7)
  v_mfma_f32_16x16x32_bf16 v[28:31], v[60:63], v[244:247], v[28:31]
  v_mfma_f32_16x16x32_bf16 v[32:35], v[60:63], v[248:251], v[32:35]
  v_mfma_f32_16x16x32_bf16 v[36:39], v[60:63], v[252:255], v[36:39]
  s_mov_b32 s47, s49
  s_nop 6
L_loop_46:
  s_waitcnt vmcnt(6)
  s_cmp_eq_u32 s44, 0
  s_cbranch_scc0 L_have_54
  v_readfirstlane_b32 s60, v8
  s_add_u32 s60, s60, 64
  s_mov_b32 s44, 1
  s_sub_u32 s43, s60, 304
  s_add_u32 s43, s43, 3584
  s_sub_u32 s58, s60, 240
  s_mul_i32 s58, s58, 4
  s_add_u32 s58, s58, 3328
  s_cmp_lt_u32 s60, 304
  s_cselect_b32 s43, s58, s43
  s_cselect_b32 s44, 4, s44
  s_sub_u32 s58, s60, 176
  s_mul_i32 s58, s58, 8
  s_add_u32 s58, s58, 2816
  s_cmp_lt_u32 s60, 240
  s_cselect_b32 s43, s58, s43
  s_cselect_b32 s44, 8, s44
  s_sub_u32 s58, s60, 0
  s_mul_i32 s58, s58, 16
  s_add_u32 s58, s58, 0
  s_cmp_lt_u32 s60, 176
  s_cselect_b32 s43, s58, s43
  s_cselect_b32 s44, 16, s44
L_have_54:
  s_lshr_b32 s49, s43, 10
  s_mul_i32 s58, s49, 100663296
  s_and_b32 s59, s43, 1023
  s_mul_i32 s59, s59, 3072
  s_add_u32 s45, s58, s59
  s_add_u32 s45, s45, s50
  s_cmp_lt_u32 s43, 4096
  s_cselect_b32 s6, 402653184, 0
  s_cselect_b32 s10, 402653184, 0
  s_cselect_b32 s46, 1, 0
  s_cbranch_scc0 L_dummy_57
  s_add_u32 s43, s43, 1
  s_sub_u32 s44, s44, 1
  s_cmp_eq_u32 s44, 0
  s_cbranch_scc1 L_claim_55
L_dummy_57:
  buffer_load_dword v8, v6, s[12:15], 0 offen
  s_branch L_claimed_56
L_claim_55:
  s_mov_b64 exec, 1
  global_atomic_add v8, v6, v7, s[52:53] sc0
  s_mov_b64 exec, -1
L_claimed_56:
  s_cmp_eq_u32 s47, s48
  s_cbranch_scc1 L_nosw_47
  v_add_f32_dpp v15, v15, v15 row_ror:8 row_mask:0xf bank_mask:0xf
  s_nop 0
  v_readlane_b32 s58, v15, 0
  v_readlane_b32 s59, v15, 16
  v_readlane_b32 s60, v15, 32
  v_readlane_b32 s61, v15, 48
  v_mov_b32 v15, s58
  v_add_f32 v15, s59, v15
  v_add_f32 v15, s60, v15
  v_add_f32 v15, s61, v15
  s_lshl_b32 s58, s48, 3
  s_add_u32 s58, s58, s42
  s_mul_i32 s58, s58, 1600
  s_add_u32 s58, s58, 22528
  v_lshrrev_b32 v44, 5, v1
  v_mul_u32_u24 v44, 768, v44
  v_and_b32 v45, 7, v1
  v_lshlrev_b32 v45, 5, v45
  v_add_u32 v44, v44, v45
  v_bfe_u32 v45, v1, 4, 1
  v_lshlrev_b32 v45, 4, v45
  v_add_u32 v44, v44, v45
  v_add_u32 v44, s58, v44
  s_mov_b32 exec_lo, 0x00ff00ff
  s_mov_b32 exec_hi, 0xff00ff00
  ds_write_b128 v44, v[28:31] offset:0
  ds_write_b128 v44, v[32:35] offset:256
  ds_write_b128 v44, v[36:39] offset:512
  s_mov_b64 exec, 1
  v_mov_b32 v46, s58
  ds_write_b64 v46, v[14:15] offset:1536
  s_mov_b64 exec, -1
  v_mov_b32 v28, 0
  v_mov_b32 v29, 0
  v_mov_b32 v30, 0
  v_mov_b32 v31, 0
  v_mov_b32 v32, 0
  v_mov_b32 v33, 0
  v_mov_b32 v34, 0
  v_mov_b32 v35, 0
  v_mov_b32 v36, 0
  v_mov_b32 v37, 0
  v_mov_b32 v38, 0
  v_mov_b32 v39, 0
  v_mov_b32 v15, 0
  v_mov_b32 v13, 0xf149f2ca
  v_mov_b32 v14, 0xf149f2ca
  s_mov_b32 s48, s47
  s_mul_i32 s58, s48, 384
  v_and_b32 v44, 7, v1
  v_lshlrev_b32 v44, 4, v44
  v_add_u32 v44, s58, v44
  ds_read_b128 v[16:19], v44 offset:10240
  ds_read_b128 v[20:23], v44 offset:10368
  ds_read_b128 v[24:27], v44 offset:10496
  s_waitcnt lgkmcnt(0)
L_nosw_47:
  s_waitcnt vmcnt(4)
  v_dot2_f32_bf16 v40, v64, v16, 0
  v_dot2_f32_bf16 v44, v68, v20, 0
  v_dot2_f32_bf16 v45, v72, v24, 0
  v_dot2_f32_bf16 v40, v65, v17, v40
  v_dot2_f32_bf16 v44, v69, v21, v44
  v_dot2_f32_bf16 v45, v73, v25, v45
  v_dot2_f32_bf16 v40, v66, v18, v40
  v_dot2_f32_bf16 v44, v70, v22, v44
  v_dot2_f32_bf16 v45, v74, v26, v45
  v_dot2_f32_bf16 v40, v67, v19, v40
  v_dot2_f32_bf16 v44, v71, v23, v44
  v_dot2_f32_bf16 v45, v75, v27, v45
  buffer_load_dwordx4 v[64:67], v2, s[4:7], s45 offen offset:0 nt
  buffer_load_dwordx4 v[68:71], v2, s[4:7], s45 offen offset:128 nt
  buffer_load_dwordx4 v[72:75], v2, s[4:7], s45 offen offset:256 nt
  v_add_f32 v40, v40, v44
  v_add_f32 v40, v40, v45
  s_nop 1
  v_add_f32_dpp v40, v40, v40 quad_perm:[1,0,3,2] row_mask:0xf bank_mask:0xf
  s_nop 1
  v_add_f32_dpp v40, v40, v40 quad_perm:[2,3,0,1] row_mask:0xf bank_mask:0xf
  s_nop 1
  v_add_f32_dpp v40, v40, v40 row_half_mirror row_mask:0xf bank_mask:0xf
  v_cvt_pk_bf16_f32 v40, v40, v40
  v_and_b32 v40, s70, v40
  v_mul_f32 v40, s66, v40
  v_cvt_pk_bf16_f32 v40, v40, v40
  v_and_b32 v40, s70, v40
  v_cmp_gt_f32 vcc, v40, v13
  s_nop 4
  s_cbranch_vccz L_nomax_58
  v_mov_b32 v44, v40
  s_nop 1
  v_max_f32_dpp v44, v44, v44 row_ror:8 row_mask:0xf bank_mask:0xf
  s_nop 0
  v_readlane_b32 s58, v44, 0
  v_readlane_b32 s59, v44, 16
  v_readlane_b32 s60, v44, 32
  v_readlane_b32 s61, v44, 48
  v_mov_b32 v44, s58
  v_max_f32 v44, s59, v44
  v_max_f32 v44, s60, v44
  v_max_f32 v44, s61, v44
  v_max_f32 v13, v13, v44
  v_mul_f32 v45, s67, v13
  v_sub_f32 v46, v14, v45
  v_exp_f32 v46, v46
  v_mov_b32 v14, v45
  v_mul_f32 v28, v28, v46
  v_mul_f32 v29, v29, v46
  v_mul_f32 v30, v30, v46
  v_mul_f32 v31, v31, v46
  v_mul_f32 v32, v32, v46
  v_mul_f32 v33, v33, v46
  v_mul_f32 v34, v34, v46
  v_mul_f32 v35, v35, v46
  v_mul_f32 v36, v36, v46
  v_mul_f32 v37, v37, v46
  v_mul_f32 v38, v38, v46
  v_mul_f32 v39, v39, v46
  v_mul_f32 v15, v15, v46
  s_nop 1
L_nomax_58:
  v_fma_f32 v40, v40, s67, -v14
  v_exp_f32 v40, v40
  s_nop 0
  v_add_f32 v15, v15, v40
  v_cvt_pk_bf16_f32 v44, v40, v40
  v_and_b32 v48, v44, v9
  v_and_b32 v49, v44, v10
  v_and_b32 v50, v44, v11
  v_and_b32 v51, v44, v12
  s_waitcnt vmcnt(4)
  s_nop 0
  v_mfma_f32_16x16x32_bf16 v[28:31], v[48:51], v[76:79], v[28:31]
  v_mfma_f32_16x16x32_bf16 v[32:35], v[48:51], v[80:83], v[32:35]
  v_mfma_f32_16x16x32_bf16 v[36:39], v[48:51], v[84:87], v[36:39]
  buffer_load_dwordx4 v[76:79], v2, s[8:11], s45 offen offset:0 nt
  buffer_load_dwordx4 v[80:83], v2, s[8:11], s45 offen offset:128 nt
  buffer_load_dwordx4 v[84:87], v2, s[8:11], s45 offen offset:256 nt
  s_mov_b32 s47, s49
  s_cmp_eq_u32 s46, 1
  s_nop 2
  s_cbranch_scc1 L_loop_46
  s_waitcnt vmcnt(0)
  v_add_f32_dpp v15, v15, v15 row_ror:8 row_mask:0xf bank_mask:0xf
  s_nop 0
  v_readlane_b32 s58, v15, 0
  v_readlane_b32 s59, v15, 16
  v_readlane_b32 s60, v15, 32
  v_readlane_b32 s61, v15, 48
  v_mov_b32 v15, s58
  v_add_f32 v15, s59, v15
  v_add_f32 v15, s60, v15
  v_add_f32 v15, s61, v15
  s_lshl_b32 s58, s48, 3
  s_add_u32 s58, s58, s42
  s_mul_i32 s58, s58, 1600
  s_add_u32 s58, s58, 22528
  v_lshrrev_b32 v44, 5, v1
  v_mul_u32_u24 v44, 768, v44
  v_and_b32 v45, 7, v1
  v_lshlrev_b32 v45, 5, v45
  v_add_u32 v44, v44, v45
  v_bfe_u32 v45, v1, 4, 1
  v_lshlrev_b32 v45, 4, v45
  v_add_u32 v44, v44, v45
  v_add_u32 v44, s58, v44
  s_mov_b32 exec_lo, 0x00ff00ff
  s_mov_b32 exec_hi, 0xff00ff00
  ds_write_b128 v44, v[28:31] offset:0
  ds_write_b128 v44, v[32:35] offset:256
  ds_write_b128 v44, v[36:39] offset:512
  s_mov_b64 exec, 1
  v_mov_b32 v46, s58
  ds_write_b64 v46, v[14:15] offset:1536
  s_mov_b64 exec, -1
  s_waitcnt lgkmcnt(0)
  s_cmp_lt_u32 s42, 3
  s_cbranch_scc1 L_ws_59
  s_sub_u32 s62, s42, 3
  s_cmp_eq_u32 s51, 0
  s_cbranch_scc1 L_dw2_60
  v_lshrrev_b32 v248, 3, v1
  v_mul_u32_u24 v248, 3072, v248
  v_and_b32 v249, 7, v1
  v_lshlrev_b32 v249, 4, v249
  v_add_u32 v248, v248, v249
  s_mul_i32 s3, s41, 245760
  s_lshl_b32 s58, s40, 7
  s_add_u32 s3, s3, s58
  v_add_u32 v248, s3, v248
  v_lshrrev_b32 v248, 4, v1
  v_mul_u32_u24 v248, 1280, v248
  v_and_b32 v249, 15, v1
  v_min_u32 v249, 9, v249
  v_lshlrev_b32 v249, 4, v249
  v_add_u32 v248, v248, v249
  s_mul_i32 s3, s40, 81920
  s_mul_i32 s58, s41, 160
  s_add_u32 s3, s3, s58
  v_add_u32 v248, s3, v248
  global_load_dwordx4 v[144:147], v248, s[32:33] nt
  v_add_u32 v248, 5120, v248
  global_load_dwordx4 v[148:151], v248, s[32:33] nt
  v_add_u32 v248, 5120, v248
  global_load_dwordx4 v[152:155], v248, s[32:33] nt
  v_add_u32 v248, 5120, v248
  global_load_dwordx4 v[156:159], v248, s[32:33] nt
  v_add_u32 v248, 5120, v248
  global_load_dwordx4 v[160:163], v248, s[32:33] nt
  v_add_u32 v248, 5120, v248
  global_load_dwordx4 v[164:167], v248, s[32:33] nt
  v_add_u32 v248, 5120, v248
  global_load_dwordx4 v[168:171], v248, s[32:33] nt
  v_add_u32 v248, 5120, v248
  global_load_dwordx4 v[172:175], v248, s[32:33] nt
  v_add_u32 v248, 5120, v248
  global_load_dwordx4 v[176:179], v248, s[32:33] nt
  v_add_u32 v248, 5120, v248
  global_load_dwordx4 v[180:183], v248, s[32:33] nt
  v_add_u32 v248, 5120, v248
  global_load_dwordx4 v[184:187], v248, s[32:33] nt
  v_add_u32 v248, 5120, v248
  global_load_dwordx4 v[188:191], v248, s[32:33] nt
  v_add_u32 v248, 5120, v248
  global_load_dwordx4 v[192:195], v248, s[32:33] nt
  v_add_u32 v248, 5120, v248
  global_load_dwordx4 v[196:199], v248, s[32:33] nt
  v_add_u32 v248, 5120, v248
  global_load_dwordx4 v[200:203], v248, s[32:33] nt
  v_add_u32 v248, 5120, v248
  global_load_dwordx4 v[204:207], v248, s[32:33] nt
  s_nop 0
L_dw2_60:
  v_lshrrev_b32 v88, 4, v1
  v_mul_u32_u24 v88, 1280, v88
  v_and_b32 v89, 15, v1
  v_lshlrev_b32 v89, 4, v89
  v_add_u32 v88, v88, v89
  s_mul_i32 s3, s2, 30720
  s_lshl_b32 s58, s62, 8
  s_add_u32 s3, s3, s58
  v_add_u32 v88, s3, v88
  global_load_dwordx4 v[64:67], v88, s[24:25] nt
  v_add_u32 v88, 5120, v88
  global_load_dwordx4 v[68:71], v88, s[24:25] nt
  v_add_u32 v88, 5120, v88
  global_load_dwordx4 v[72:75], v88, s[24:25] nt
  v_add_u32 v88, 5120, v88
  global_load_dwordx4 v[76:79], v88, s[24:25] nt
  v_add_u32 v88, 5120, v88
  global_load_dwordx4 v[80:83], v88, s[24:25] nt
  v_add_u32 v88, 5120, v88
  global_load_dwordx4 v[84:87], v88, s[24:25] nt
  s_nop 0
L_ws_59:
  s_barrier
  s_cmp_ge_u32 s42, 3
  s_cbranch_scc1 L_w37_62
  v_mul_u32_u24 v48, 1366, v0
  v_lshrrev_b32 v48, 16, v48
  v_mul_u32_u24 v49, 12800, v48
  v_add_u32 v49, 22528, v49
  ds_read_b64 v[52:53], v49 offset:1536
  ds_read_b64 v[54:55], v49 offset:3136
  ds_read_b64 v[56:57], v49 offset:4736
  ds_read_b64 v[58:59], v49 offset:6336
  ds_read_b64 v[60:61], v49 offset:7936
  ds_read_b64 v[62:63], v49 offset:9536
  ds_read_b64 v[64:65], v49 offset:11136
  ds_read_b64 v[66:67], v49 offset:12736
  v_mul_u32_u24 v50, 48, v48
  v_sub_u32 v50, v0, v50
  v_lshlrev_b32 v50, 4, v50
  v_add_u32 v51, v49, v50
  ds_read_b128 v[72:75], v51 offset:0
  ds_read_b128 v[76:79], v51 offset:768
  ds_read_b128 v[80:83], v51 offset:1600
  ds_read_b128 v[84:87], v51 offset:2368
  ds_read_b128 v[88:91], v51 offset:3200
  ds_read_b128 v[92:95], v51 offset:3968
  ds_read_b128 v[96:99], v51 offset:4800
  ds_read_b128 v[100:103], v51 offset:5568
  ds_read_b128 v[104:107], v51 offset:6400
  ds_read_b128 v[108:111], v51 offset:7168
  ds_read_b128 v[112:115], v51 offset:8000
  ds_read_b128 v[116:119], v51 offset:8768
  ds_read_b128 v[120:123], v51 offset:9600
  ds_read_b128 v[124:127], v51 offset:10368
  ds_read_b128 v[128:131], v51 offset:11200
  ds_read_b128 v[132:135], v51 offset:11968
  s_waitcnt lgkmcnt(0)
  v_max3_f32 v50, v52, v54, v56
  v_max3_f32 v50, v50, v58, v60
  v_max3_f32 v50, v50, v62, v64
  v_max_f32 v50, v50, v66
  v_sub_f32 v52, v52, v50
  v_sub_f32 v54, v54, v50
  v_sub_f32 v56, v56, v50
  v_sub_f32 v58, v58, v50
  v_sub_f32 v60, v60, v50
  v_sub_f32 v62, v62, v50
  v_sub_f32 v64, v64, v50
  v_sub_f32 v66, v66, v50
  v_exp_f32 v52, v52
  v_exp_f32 v54, v54
  v_exp_f32 v56, v56
  v_exp_f32 v58, v58
  v_exp_f32 v60, v60
  v_exp_f32 v62, v62
  v_exp_f32 v64, v64
  v_exp_f32 v66, v66
  v_mul_f32 v51, v52, v53
  v_fma_f32 v51, v54, v55, v51
  v_fma_f32 v51, v56, v57, v51
  v_fma_f32 v51, v58, v59, v51
  v_fma_f32 v51, v60, v61, v51
  v_fma_f32 v51, v62, v63, v51
  v_fma_f32 v51, v64, v65, v51
  v_fma_f32 v51, v66, v67, v51
  v_add_f32 v68, v72, v76
  v_mul_f32 v68, v68, v52
  v_add_f32 v69, v73, v77
  v_mul_f32 v69, v69, v52
  v_add_f32 v70, v74, v78
  v_mul_f32 v70, v70, v52
  v_add_f32 v71, v75, v79
  v_mul_f32 v71, v71, v52
  v_add_f32 v80, v80, v84
  v_fma_f32 v68, v80, v54, v68
  v_add_f32 v81, v81, v85
  v_fma_f32 v69, v81, v54, v69
  v_add_f32 v82, v82, v86
  v_fma_f32 v70, v82, v54, v70
  v_add_f32 v83, v83, v87
  v_fma_f32 v71, v83, v54, v71
  v_add_f32 v88, v88, v92
  v_fma_f32 v68, v88, v56, v68
  v_add_f32 v89, v89, v93
  v_fma_f32 v69, v89, v56, v69
  v_add_f32 v90, v90, v94
  v_fma_f32 v70, v90, v56, v70
  v_add_f32 v91, v91, v95
  v_fma_f32 v71, v91, v56, v71
  v_add_f32 v96, v96, v100
  v_fma_f32 v68, v96, v58, v68
  v_add_f32 v97, v97, v101
  v_fma_f32 v69, v97, v58, v69
  v_add_f32 v98, v98, v102
  v_fma_f32 v70, v98, v58, v70
  v_add_f32 v99, v99, v103
  v_fma_f32 v71, v99, v58, v71
  v_add_f32 v104, v104, v108
  v_fma_f32 v68, v104, v60, v68
  v_add_f32 v105, v105, v109
  v_fma_f32 v69, v105, v60, v69
  v_add_f32 v106, v106, v110
  v_fma_f32 v70, v106, v60, v70
  v_add_f32 v107, v107, v111
  v_fma_f32 v71, v107, v60, v71
  v_add_f32 v112, v112, v116
  v_fma_f32 v68, v112, v62, v68
  v_add_f32 v113, v113, v117
  v_fma_f32 v69, v113, v62, v69
  v_add_f32 v114, v114, v118
  v_fma_f32 v70, v114, v62, v70
  v_add_f32 v115, v115, v119
  v_fma_f32 v71, v115, v62, v71
  v_add_f32 v120, v120, v124
  v_fma_f32 v68, v120, v64, v68
  v_add_f32 v121, v121, v125
  v_fma_f32 v69, v121, v64, v69
  v_add_f32 v122, v122, v126
  v_fma_f32 v70, v122, v64, v70
  v_add_f32 v123, v123, v127
  v_fma_f32 v71, v123, v64, v71
  v_add_f32 v128, v128, v132
  v_fma_f32 v68, v128, v66, v68
  v_add_f32 v129, v129, v133
  v_fma_f32 v69, v129, v66, v69
  v_add_f32 v130, v130, v134
  v_fma_f32 v70, v130, v66, v70
  v_add_f32 v131, v131, v135
  v_fma_f32 v71, v131, v66, v71
  s_mul_i32 s3, s2, 3072
  s_add_u32 s3, s3, 5046272
  v_lshlrev_b32 v49, 4, v0
  v_add_u32 v49, s3, v49
  v_add_u32 v68, 0x200, v68
  v_add_u32 v69, 0x200, v69
  v_add_u32 v70, 0x200, v70
  v_add_u32 v71, 0x200, v71
  v_lshrrev_b32 v68, 10, v68
  v_lshrrev_b32 v69, 10, v69
  v_lshrrev_b32 v70, 10, v70
  v_lshrrev_b32 v71, 10, v71
  v_lshl_or_b32 v76, v69, 22, v68
  v_lshrrev_b32 v69, 10, v69
  v_lshl_or_b32 v77, v70, 12, v69
  v_lshrrev_b32 v70, 20, v70
  v_lshl_or_b32 v78, v71, 2, v70
  v_or_b32 v78, s73, v78
  v_mov_b32 v79, s71
  global_store_dwordx4 v49, v[76:79], s[38:39] sc1
  v_mul_u32_u24 v72, 48, v48
  v_cmp_eq_u32 vcc, v0, v72
  v_mov_b32 v80, v50
  v_mov_b32 v81, v51
  v_mov_b32 v82, s73
  v_mov_b32 v83, s71
  s_and_saveexec_b64 s[56:57], vcc
  s_lshl_b32 s3, s2, 6
  s_add_u32 s3, s3, 4210688
  v_lshlrev_b32 v49, 4, v48
  v_add_u32 v49, s3, v49
  global_store_dwordx4 v49, v[80:83], s[38:39] sc1
  s_mov_b64 exec, s[56:57]
  v_and_b32 v48, 7, v0
  v_lshrrev_b32 v49, 3, v0
  v_mul_u32_u24 v50, 43, v49
  v_lshrrev_b32 v50, 8, v50
  v_mul_u32_u24 v51, 6, v50
  v_sub_u32 v51, v49, v51
  v_mul_u32_u24 v52, 3072, v48
  v_mul_u32_u24 v60, 768, v50
  v_add_u32 v52, v52, v60
  v_lshlrev_b32 v60, 4, v51
  v_add_u32 v52, v52, v60
  s_mul_i32 s3, s40, 24576
  s_mul_i32 s58, s41, 96
  s_add_u32 s3, s3, s58
  s_add_u32 s3, s3, 5046272
  v_add_u32 v52, s3, v52
  v_lshlrev_b32 v53, 6, v48
  v_lshlrev_b32 v60, 4, v50
  v_add_u32 v53, v53, v60
  s_lshl_b32 s3, s40, 9
  s_add_u32 s3, s3, 4210688
  v_add_u32 v53, s3, v53
  s_mov_b64 s[54:55], exec
  s_mov_b32 s3, 0x40000
L_gpoll_64:
  global_load_dwordx4 v[56:59], v52, s[38:39] offset:0 sc1
  global_load_dwordx4 v[64:67], v53, s[38:39] offset:0 sc1
  s_waitcnt vmcnt(0)
  v_xor_b32 v254, s73, v58
  v_and_b32 v254, s74, v254
  v_xor_b32 v255, s71, v59
  v_or_b32 v255, v255, v254
  v_xor_b32 v254, s73, v66
  v_and_b32 v254, s74, v254
  v_or_b32 v255, v255, v254
  v_xor_b32 v254, s71, v67
  v_or_b32 v255, v255, v254
  v_cmp_ne_u32 vcc, 0, v255
  s_and_b64 exec, exec, vcc
  s_nop 3
  s_cbranch_execz L_gdone_65
  s_sub_u32 s3, s3, 1
  s_cbranch_scc0 L_gpoll_64
L_gdone_65:
  s_mov_b64 exec, s[54:55]
  v_lshlrev_b32 v59, 8, v58
  v_alignbit_b32 v58, v58, v57, 2
  v_alignbit_b32 v57, v57, v56, 12
  v_lshlrev_b32 v56, 10, v56
  v_and_b32 v57, s72, v57
  v_and_b32 v58, s72, v58
  v_and_b32 v59, s72, v59
  v_mov_b32 v54, v64
  v_mov_b32 v55, v65
  v_mov_b32 v60, v54
  s_nop 1
  v_max_f32_dpp v60, v60, v60 quad_perm:[1,0,3,2] row_mask:0xf bank_mask:0xf
  s_nop 1
  v_max_f32_dpp v60, v60, v60 quad_perm:[2,3,0,1] row_mask:0xf bank_mask:0xf
  s_nop 1
  v_max_f32_dpp v60, v60, v60 row_half_mirror row_mask:0xf bank_mask:0xf
  v_sub_f32 v60, v54, v60
  v_exp_f32 v60, v60
  s_nop 0
  v_mul_f32 v61, v60, v55
  v_mul_f32 v56, v56, v60
  v_mul_f32 v57, v57, v60
  v_mul_f32 v58, v58, v60
  v_mul_f32 v59, v59, v60
  v_add_f32_dpp v61, v61, v61 quad_perm:[1,0,3,2] row_mask:0xf bank_mask:0xf
  v_add_f32_dpp v56, v56, v56 quad_perm:[1,0,3,2] row_mask:0xf bank_mask:0xf
  v_add_f32_dpp v57, v57, v57 quad_perm:[1,0,3,2] row_mask:0xf bank_mask:0xf
  v_add_f32_dpp v58, v58, v58 quad_perm:[1,0,3,2] row_mask:0xf bank_mask:0xf
  v_add_f32_dpp v59, v59, v59 quad_perm:[1,0,3,2] row_mask:0xf bank_mask:0xf
  v_add_f32_dpp v61, v61, v61 quad_perm:[2,3,0,1] row_mask:0xf bank_mask:0xf
  v_add_f32_dpp v56, v56, v56 quad_perm:[2,3,0,1] row_mask:0xf bank_mask:0xf
  v_add_f32_dpp v57, v57, v57 quad_perm:[2,3,0,1] row_mask:0xf bank_mask:0xf
  v_add_f32_dpp v58, v58, v58 quad_perm:[2,3,0,1] row_mask:0xf bank_mask:0xf
  v_add_f32_dpp v59, v59, v59 quad_perm:[2,3,0,1] row_mask:0xf bank_mask:0xf
  v_add_f32_dpp v61, v61, v61 row_half_mirror row_mask:0xf bank_mask:0xf
  v_add_f32_dpp v56, v56, v56 row_half_mirror row_mask:0xf bank_mask:0xf
  v_add_f32_dpp v57, v57, v57 row_half_mirror row_mask:0xf bank_mask:0xf
  v_add_f32_dpp v58, v58, v58 row_half_mirror row_mask:0xf bank_mask:0xf
  v_add_f32_dpp v59, v59, v59 row_half_mirror row_mask:0xf bank_mask:0xf
  v_rcp_f32 v60, v61
  s_nop 0
  v_mul_f32 v62, v56, v60
  v_fma_f32 v63, -v62, v61, v56
  v_fma_f32 v56, v63, v60, v62
  v_cvt_pk_bf16_f32 v56, v56, v56
  v_mul_f32 v62, v57, v60
  v_fma_f32 v63, -v62, v61, v57
  v_fma_f32 v57, v63, v60, v62
  v_cvt_pk_bf16_f32 v57, v57, v57
  v_mul_f32 v62, v58, v60
  v_fma_f32 v63, -v62, v61, v58
  v_fma_f32 v58, v63, v60, v62
  v_cvt_pk_bf16_f32 v58, v58, v58
  v_mul_f32 v62, v59, v60
  v_fma_f32 v63, -v62, v61, v59
  v_fma_f32 v59, v63, v60, v62
  v_cvt_pk_bf16_f32 v59, v59, v59
  v_mul_u32_u24 v52, 96, v50
  v_lshlrev_b32 v60, 4, v51
  v_add_u32 v52, v52, v60
  v_cmp_eq_u32 vcc, 0, v48
  s_and_saveexec_b64 s[56:57], vcc
  ds_write_b128 v52, v[56:59] offset:12800
  s_mov_b64 exec, s[56:57]
  s_waitcnt lgkmcnt(0)
  s_nop 0
  s_branch L_jb_63
L_w37_62:
  s_cmp_eq_u32 s51, 0
  s_cbranch_scc1 L_jb_63
  v_mov_b32 v208, 0
  v_mov_b32 v209, 0
  v_mov_b32 v210, 0
  v_mov_b32 v211, 0
  v_mov_b32 v212, 0
  v_mov_b32 v213, 0
  v_mov_b32 v214, 0
  v_mov_b32 v215, 0
  v_bfe_u32 v252, v1, 3, 1
  v_mul_u32_u24 v252, 256, v252
  v_lshrrev_b32 v220, 4, v1
  v_lshlrev_b32 v220, 2, v220
  v_add_u32 v252, v252, v220
  ds_read_b32 v220, v252 offset:11776
  ds_read_b32 v221, v252 offset:12288
  ds_read_b32 v222, v252 offset:11792
  ds_read_b32 v223, v252 offset:12304
  ds_read_b32 v224, v252 offset:11808
  ds_read_b32 v225, v252 offset:12320
  ds_read_b32 v226, v252 offset:11824
  ds_read_b32 v227, v252 offset:12336
  ds_read_b32 v228, v252 offset:11840
  ds_read_b32 v229, v252 offset:12352
  ds_read_b32 v230, v252 offset:11856
  ds_read_b32 v231, v252 offset:12368
  ds_read_b32 v232, v252 offset:11872
  ds_read_b32 v233, v252 offset:12384
  ds_read_b32 v234, v252 offset:11888
  ds_read_b32 v235, v252 offset:12400
  ds_read_b32 v236, v252 offset:11904
  ds_read_b32 v237, v252 offset:12416
  ds_read_b32 v238, v252 offset:11920
  ds_read_b32 v239, v252 offset:12432
  ds_read_b32 v240, v252 offset:11936
  ds_read_b32 v241, v252 offset:12448
  ds_read_b32 v242, v252 offset:11952
  ds_read_b32 v243, v252 offset:12464
  ds_read_b32 v244, v252 offset:11968
  ds_read_b32 v245, v252 offset:12480
  ds_read_b32 v246, v252 offset:11984
  ds_read_b32 v247, v252 offset:12496
  ds_read_b32 v248, v252 offset:12000
  ds_read_b32 v249, v252 offset:12512
  ds_read_b32 v250, v252 offset:12016
  ds_read_b32 v251, v252 offset:12528
  s_waitcnt vmcnt(0) lgkmcnt(0)
  v_and_b32 v216, v220, v9
  v_and_b32 v217, v220, v10
  v_and_b32 v218, v220, v11
  v_and_b32 v219, v220, v12
  s_nop 1
  v_mfma_f32_16x16x32_bf16 v[208:211], v[216:219], v[144:147], v[208:211]
  v_and_b32 v216, v221, v9
  v_and_b32 v217, v221, v10
  v_and_b32 v218, v221, v11
  v_and_b32 v219, v221, v12
  s_nop 1
  v_mfma_f32_16x16x32_bf16 v[212:215], v[216:219], v[144:147], v[212:215]
  v_and_b32 v216, v222, v9
  v_and_b32 v217, v222, v10
  v_and_b32 v218, v222, v11
  v_and_b32 v219, v222, v12
  s_nop 1
  v_mfma_f32_16x16x32_bf16 v[208:211], v[216:219], v[148:151], v[208:211]
  v_and_b32 v216, v223, v9
  v_and_b32 v217, v223, v10
  v_and_b32 v218, v223, v11
  v_and_b32 v219, v223, v12
  s_nop 1
  v_mfma_f32_16x16x32_bf16 v[212:215], v[216:219], v[148:151], v[212:215]
  v_and_b32 v216, v224, v9
  v_and_b32 v217, v224, v10
  v_and_b32 v218, v224, v11
  v_and_b32 v219, v224, v12
  s_nop 1
  v_mfma_f32_16x16x32_bf16 v[208:211], v[216:219], v[152:155], v[208:211]
  v_and_b32 v216, v225, v9
  v_and_b32 v217, v225, v10
  v_and_b32 v218, v225, v11
  v_and_b32 v219, v225, v12
  s_nop 1
  v_mfma_f32_16x16x32_bf16 v[212:215], v[216:219], v[152:155], v[212:215]
  v_and_b32 v216, v226, v9
  v_and_b32 v217, v226, v10
  v_and_b32 v218, v226, v11
  v_and_b32 v219, v226, v12
  s_nop 1
  v_mfma_f32_16x16x32_bf16 v[208:211], v[216:219], v[156:159], v[208:211]
  v_and_b32 v216, v227, v9
  v_and_b32 v217, v227, v10
  v_and_b32 v218, v227, v11
  v_and_b32 v219, v227, v12
  s_nop 1
  v_mfma_f32_16x16x32_bf16 v[212:215], v[216:219], v[156:159], v[212:215]
  v_and_b32 v216, v228, v9
  v_and_b32 v217, v228, v10
  v_and_b32 v218, v228, v11
  v_and_b32 v219, v228, v12
  s_nop 1
  v_mfma_f32_16x16x32_bf16 v[208:211], v[216:219], v[160:163], v[208:211]
  v_and_b32 v216, v229, v9
  v_and_b32 v217, v229, v10
  v_and_b32 v218, v229, v11
  v_and_b32 v219, v229, v12
  s_nop 1
  v_mfma_f32_16x16x32_bf16 v[212:215], v[216:219], v[160:163], v[212:215]
  v_and_b32 v216, v230, v9
  v_and_b32 v217, v230, v10
  v_and_b32 v218, v230, v11
  v_and_b32 v219, v230, v12
  s_nop 1
  v_mfma_f32_16x16x32_bf16 v[208:211], v[216:219], v[164:167], v[208:211]
  v_and_b32 v216, v231, v9
  v_and_b32 v217, v231, v10
  v_and_b32 v218, v231, v11
  v_and_b32 v219, v231, v12
  s_nop 1
  v_mfma_f32_16x16x32_bf16 v[212:215], v[216:219], v[164:167], v[212:215]
  v_and_b32 v216, v232, v9
  v_and_b32 v217, v232, v10
  v_and_b32 v218, v232, v11
  v_and_b32 v219, v232, v12
  s_nop 1
  v_mfma_f32_16x16x32_bf16 v[208:211], v[216:219], v[168:171], v[208:211]
  v_and_b32 v216, v233, v9
  v_and_b32 v217, v233, v10
  v_and_b32 v218, v233, v11
  v_and_b32 v219, v233, v12
  s_nop 1
  v_mfma_f32_16x16x32_bf16 v[212:215], v[216:219], v[168:171], v[212:215]
  v_and_b32 v216, v234, v9
  v_and_b32 v217, v234, v10
  v_and_b32 v218, v234, v11
  v_and_b32 v219, v234, v12
  s_nop 1
  v_mfma_f32_16x16x32_bf16 v[208:211], v[216:219], v[172:175], v[208:211]
  v_and_b32 v216, v235, v9
  v_and_b32 v217, v235, v10
  v_and_b32 v218, v235, v11
  v_and_b32 v219, v235, v12
  s_nop 1
  v_mfma_f32_16x16x32_bf16 v[212:215], v[216:219], v[172:175], v[212:215]
  v_and_b32 v216, v236, v9
  v_and_b32 v217, v236, v10
  v_and_b32 v218, v236, v11
  v_and_b32 v219, v236, v12
  s_nop 1
  v_mfma_f32_16x16x32_bf16 v[208:211], v[216:219], v[176:179], v[208:211]
  v_and_b32 v216, v237, v9
  v_and_b32 v217, v237, v10
  v_and_b32 v218, v237, v11
  v_and_b32 v219, v237, v12
  s_nop 1
  v_mfma_f32_16x16x32_bf16 v[212:215], v[216:219], v[176:179], v[212:215]
  v_and_b32 v216, v238, v9
  v_and_b32 v217, v238, v10
  v_and_b32 v218, v238, v11
  v_and_b32 v219, v238, v12
  s_nop 1
  v_mfma_f32_16x16x32_bf16 v[208:211], v[216:219], v[180:183], v[208:211]
  v_and_b32 v216, v239, v9
  v_and_b32 v217, v239, v10
  v_and_b32 v218, v239, v11
  v_and_b32 v219, v239, v12
  s_nop 1
  v_mfma_f32_16x16x32_bf16 v[212:215], v[216:219], v[180:183], v[212:215]
  v_and_b32 v216, v240, v9
  v_and_b32 v217, v240, v10
  v_and_b32 v218, v240, v11
  v_and_b32 v219, v240, v12
  s_nop 1
  v_mfma_f32_16x16x32_bf16 v[208:211], v[216:219], v[184:187], v[208:211]
  v_and_b32 v216, v241, v9
  v_and_b32 v217, v241, v10
  v_and_b32 v218, v241, v11
  v_and_b32 v219, v241, v12
  s_nop 1
  v_mfma_f32_16x16x32_bf16 v[212:215], v[216:219], v[184:187], v[212:215]
  v_and_b32 v216, v242, v9
  v_and_b32 v217, v242, v10
  v_and_b32 v218, v242, v11
  v_and_b32 v219, v242, v12
  s_nop 1
  v_mfma_f32_16x16x32_bf16 v[208:211], v[216:219], v[188:191], v[208:211]
  v_and_b32 v216, v243, v9
  v_and_b32 v217, v243, v10
  v_and_b32 v218, v243, v11
  v_and_b32 v219, v243, v12
  s_nop 1
  v_mfma_f32_16x16x32_bf16 v[212:215], v[216:219], v[188:191], v[212:215]
  v_and_b32 v216, v244, v9
  v_and_b32 v217, v244, v10
  v_and_b32 v218, v244, v11
  v_and_b32 v219, v244, v12
  s_nop 1
  v_mfma_f32_16x16x32_bf16 v[208:211], v[216:219], v[192:195], v[208:211]
  v_and_b32 v216, v245, v9
  v_and_b32 v217, v245, v10
  v_and_b32 v218, v245, v11
  v_and_b32 v219, v245, v12
  s_nop 1
  v_mfma_f32_16x16x32_bf16 v[212:215], v[216:219], v[192:195], v[212:215]
  v_and_b32 v216, v246, v9
  v_and_b32 v217, v246, v10
  v_and_b32 v218, v246, v11
  v_and_b32 v219, v246, v12
  s_nop 1
  v_mfma_f32_16x16x32_bf16 v[208:211], v[216:219], v[196:199], v[208:211]
  v_and_b32 v216, v247, v9
  v_and_b32 v217, v247, v10
  v_and_b32 v218, v247, v11
  v_and_b32 v219, v247, v12
  s_nop 1
  v_mfma_f32_16x16x32_bf16 v[212:215], v[216:219], v[196:199], v[212:215]
  v_and_b32 v216, v248, v9
  v_and_b32 v217, v248, v10
  v_and_b32 v218, v248, v11
  v_and_b32 v219, v248, v12
  s_nop 1
  v_mfma_f32_16x16x32_bf16 v[208:211], v[216:219], v[200:203], v[208:211]
  v_and_b32 v216, v249, v9
  v_and_b32 v217, v249, v10
  v_and_b32 v218, v249, v11
  v_and_b32 v219, v249, v12
  s_nop 1
  v_mfma_f32_16x16x32_bf16 v[212:215], v[216:219], v[200:203], v[212:215]
  v_and_b32 v216, v250, v9
  v_and_b32 v217, v250, v10
  v_and_b32 v218, v250, v11
  v_and_b32 v219, v250, v12
  s_nop 1
  v_mfma_f32_16x16x32_bf16 v[208:211], v[216:219], v[204:207], v[208:211]
  v_and_b32 v216, v251, v9
  v_and_b32 v217, v251, v10
  v_and_b32 v218, v251, v11
  v_and_b32 v219, v251, v12
  s_nop 1
  v_mfma_f32_16x16x32_bf16 v[212:215], v[216:219], v[204:207], v[212:215]
  v_lshrrev_b32 v252, 5, v1
  v_mul_u32_u24 v252, 2560, v252
  v_and_b32 v220, 15, v1
  v_lshlrev_b32 v220, 5, v220
  v_add_u32 v252, v252, v220
  v_bfe_u32 v220, v1, 4, 1
  v_lshlrev_b32 v220, 4, v220
  v_add_u32 v252, v252, v220
  s_mul_i32 s3, s40, 10240
  s_mul_i32 s58, s41, 320
  s_add_u32 s3, s3, s58
  s_add_u32 s3, s3, 8912896
  v_add_u32 v252, s3, v252
  v_add_u32 v208, 0x200, v208
  v_add_u32 v209, 0x200, v209
  v_add_u32 v210, 0x200, v210
  v_add_u32 v211, 0x200, v211
  v_lshrrev_b32 v208, 10, v208
  v_lshrrev_b32 v209, 10, v209
  v_lshrrev_b32 v210, 10, v210
  v_lshrrev_b32 v211, 10, v211
  v_lshl_or_b32 v224, v209, 22, v208
  v_lshrrev_b32 v209, 10, v209
  v_lshl_or_b32 v225, v210, 12, v209
  v_lshrrev_b32 v210, 20, v210
  v_lshl_or_b32 v226, v211, 2, v210
  v_or_b32 v226, s73, v226
  v_mov_b32 v227, s71
  v_add_u32 v212, 0x200, v212
  v_add_u32 v213, 0x200, v213
  v_add_u32 v214, 0x200, v214
  v_add_u32 v215, 0x200, v215
  v_lshrrev_b32 v212, 10, v212
  v_lshrrev_b32 v213, 10, v213
  v_lshrrev_b32 v214, 10, v214
  v_lshrrev_b32 v215, 10, v215
  v_lshl_or_b32 v228, v213, 22, v212
  v_lshrrev_b32 v213, 10, v213
  v_lshl_or_b32 v229, v214, 12, v213
  v_lshrrev_b32 v214, 20, v214
  v_lshl_or_b32 v230, v215, 2, v214
  v_or_b32 v230, s73, v230
  v_mov_b32 v231, s71
  s_mov_b32 exec_lo, 0x03ff03ff
  s_mov_b32 exec_hi, 0x03ff03ff
  global_store_dwordx4 v252, v[224:227], s[38:39] sc1
  v_add_u32 v252, 5120, v252
  global_store_dwordx4 v252, v[228:231], s[38:39] sc1
  s_mov_b64 exec, -1
  s_nop 0
L_jb_63:
  s_barrier
  s_cmp_lt_u32 s42, 3
  s_cbranch_scc1 L_ws_66
  v_mov_b32 v96, 0
  v_mov_b32 v97, 0
  v_mov_b32 v98, 0
  v_mov_b32 v99, 0
  v_mov_b32 v100, 0
  v_mov_b32 v101, 0
  v_mov_b32 v102, 0
  v_mov_b32 v103, 0
  v_bfe_u32 v140, v1, 3, 1
  v_mul_u32_u24 v140, 96, v140
  v_lshrrev_b32 v108, 4, v1
  v_lshlrev_b32 v108, 2, v108
  v_add_u32 v140, v140, v108
  ds_read_b32 v108, v140 offset:12800
  ds_read_b32 v109, v140 offset:12992
  ds_read_b32 v110, v140 offset:12816
  ds_read_b32 v111, v140 offset:13008
  ds_read_b32 v112, v140 offset:12832
  ds_read_b32 v113, v140 offset:13024
  ds_read_b32 v114, v140 offset:12848
  ds_read_b32 v115, v140 offset:13040
  ds_read_b32 v116, v140 offset:12864
  ds_read_b32 v117, v140 offset:13056
  ds_read_b32 v118, v140 offset:12880
  ds_read_b32 v119, v140 offset:13072
  s_waitcnt vmcnt(0) lgkmcnt(0)
  v_and_b32 v104, v108, v9
  v_and_b32 v105, v108, v10
  v_and_b32 v106, v108, v11
  v_and_b32 v107, v108, v12
  s_nop 1
  v_mfma_f32_16x16x32_bf16 v[96:99], v[104:107], v[64:67], v[96:99]
  v_and_b32 v104, v109, v9
  v_and_b32 v105, v109, v10
  v_and_b32 v106, v109, v11
  v_and_b32 v107, v109, v12
  s_nop 1
  v_mfma_f32_16x16x32_bf16 v[100:103], v[104:107], v[64:67], v[100:103]
  v_and_b32 v104, v110, v9
  v_and_b32 v105, v110, v10
  v_and_b32 v106, v110, v11
  v_and_b32 v107, v110, v12
  s_nop 1
  v_mfma_f32_16x16x32_bf16 v[96:99], v[104:107], v[68:71], v[96:99]
  v_and_b32 v104, v111, v9
  v_and_b32 v105, v111, v10
  v_and_b32 v106, v111, v11
  v_and_b32 v107, v111, v12
  s_nop 1
  v_mfma_f32_16x16x32_bf16 v[100:103], v[104:107], v[68:71], v[100:103]
  v_and_b32 v104, v112, v9
  v_and_b32 v105, v112, v10
  v_and_b32 v106, v112, v11
  v_and_b32 v107, v112, v12
  s_nop 1
  v_mfma_f32_16x16x32_bf16 v[96:99], v[104:107], v[72:75], v[96:99]
  v_and_b32 v104, v113, v9
  v_and_b32 v105, v113, v10
  v_and_b32 v106, v113, v11
  v_and_b32 v107, v113, v12
  s_nop 1
  v_mfma_f32_16x16x32_bf16 v[100:103], v[104:107], v[72:75], v[100:103]
  v_and_b32 v104, v114, v9
  v_and_b32 v105, v114, v10
  v_and_b32 v106, v114, v11
  v_and_b32 v107, v114, v12
  s_nop 1
  v_mfma_f32_16x16x32_bf16 v[96:99], v[104:107], v[76:79], v[96:99]
  v_and_b32 v104, v115, v9
  v_and_b32 v105, v115, v10
  v_and_b32 v106, v115, v11
  v_and_b32 v107, v115, v12
  s_nop 1
  v_mfma_f32_16x16x32_bf16 v[100:103], v[104:107], v[76:79], v[100:103]
  v_and_b32 v104, v116, v9
  v_and_b32 v105, v116, v10
  v_and_b32 v106, v116, v11
  v_and_b32 v107, v116, v12
  s_nop 1
  v_mfma_f32_16x16x32_bf16 v[96:99], v[104:107], v[80:83], v[96:99]
  v_and_b32 v104, v117, v9
  v_and_b32 v105, v117, v10
  v_and_b32 v106, v117, v11
  v_and_b32 v107, v117, v12
  s_nop 1
  v_mfma_f32_16x16x32_bf16 v[100:103], v[104:107], v[80:83], v[100:103]
  v_and_b32 v104, v118, v9
  v_and_b32 v105, v118, v10
  v_and_b32 v106, v118, v11
  v_and_b32 v107, v118, v12
  s_nop 1
  v_mfma_f32_16x16x32_bf16 v[96:99], v[104:107], v[84:87], v[96:99]
  v_and_b32 v104, v119, v9
  v_and_b32 v105, v119, v10
  v_and_b32 v106, v119, v11
  v_and_b32 v107, v119, v12
  s_nop 1
  v_mfma_f32_16x16x32_bf16 v[100:103], v[104:107], v[84:87], v[100:103]
  s_mul_i32 s3, s2, 10240
  s_add_u32 s3, s3, 6291456
  v_lshrrev_b32 v140, 5, v1
  v_mul_u32_u24 v140, 2560, v140
  v_and_b32 v108, 15, v1
  v_lshlrev_b32 v108, 5, v108
  v_add_u32 v140, v140, v108
  v_bfe_u32 v108, v1, 4, 1
  v_lshlrev_b32 v108, 4, v108
  v_add_u32 v140, v140, v108
  s_lshl_b32 s58, s62, 9
  s_add_u32 s3, s3, s58
  v_add_u32 v140, s3, v140
  v_add_u32 v96, 0x200, v96
  v_add_u32 v97, 0x200, v97
  v_add_u32 v98, 0x200, v98
  v_add_u32 v99, 0x200, v99
  v_lshrrev_b32 v96, 10, v96
  v_lshrrev_b32 v97, 10, v97
  v_lshrrev_b32 v98, 10, v98
  v_lshrrev_b32 v99, 10, v99
  v_lshl_or_b32 v112, v97, 22, v96
  v_lshrrev_b32 v97, 10, v97
  v_lshl_or_b32 v113, v98, 12, v97
  v_lshrrev_b32 v98, 20, v98
  v_lshl_or_b32 v114, v99, 2, v98
  v_or_b32 v114, s73, v114
  v_mov_b32 v115, s71
  v_add_u32 v100, 0x200, v100
  v_add_u32 v101, 0x200, v101
  v_add_u32 v102, 0x200, v102
  v_add_u32 v103, 0x200, v103
  v_lshrrev_b32 v100, 10, v100
  v_lshrrev_b32 v101, 10, v101
  v_lshrrev_b32 v102, 10, v102
  v_lshrrev_b32 v103, 10, v103
  v_lshl_or_b32 v116, v101, 22, v100
  v_lshrrev_b32 v101, 10, v101
  v_lshl_or_b32 v117, v102, 12, v101
  v_lshrrev_b32 v102, 20, v102
  v_lshl_or_b32 v118, v103, 2, v102
  v_or_b32 v118, s73, v118
  v_mov_b32 v119, s71
  global_store_dwordx4 v140, v[112:115], s[38:39] sc1
  v_add_u32 v140, 5120, v140
  global_store_dwordx4 v140, v[116:119], s[38:39] sc1
  s_nop 1
L_ws_66:
  s_cmp_ge_u32 s2, 80
  s_cbranch_scc1 L_nofinal_61
  s_mul_i32 s58, s2, 3277
  s_lshr_b32 s58, s58, 16
  s_mul_i32 s59, s58, 20
  s_sub_u32 s59, s2, s59
  s_mul_i32 s60, s58, 2560
  s_lshl_b32 s61, s59, 7
  s_add_u32 s60, s60, s61
  s_mov_b32 s62, s58
  s_mov_b32 s63, s59
  v_lshrrev_b32 v16, 3, v1
  s_lshl_b32 s3, s42, 3
  v_add_u32 v16, s3, v16
  v_mul_u32_u24 v16, 10240, v16
  v_and_b32 v17, 7, v1
  v_lshlrev_b32 v17, 4, v17
  v_add_u32 v16, v16, v17
  v_add_u32 v16, s60, v16
  v_and_b32 v19, 31, v1
  v_lshlrev_b32 v19, 1, v19
  s_mul_i32 s3, s62, 1280
  s_lshl_b32 s58, s63, 6
  s_add_u32 s3, s3, s58
  v_add_u32 v19, s3, v19
  global_load_ushort v18, v19, s[16:17]
  v_add_u32 v40, 6291456, v16
  v_add_u32 v41, 655360, v40
  v_add_u32 v42, 655360, v41
  v_add_u32 v43, 655360, v42
  v_add_u32 v44, 8912896, v16
  s_cmp_ge_u32 s42, 3
  s_nop 0
  s_cbranch_scc1 L_fin_noffn_67
  s_mov_b64 s[54:55], exec
  s_mov_b32 s3, 0x40000
L_gpoll_69:
  global_load_dwordx4 v[36:39], v44, s[38:39] offset:0 sc1
  global_load_dwordx4 v[20:23], v40, s[38:39] offset:0 sc1
  global_load_dwordx4 v[24:27], v41, s[38:39] offset:0 sc1
  global_load_dwordx4 v[28:31], v42, s[38:39] offset:0 sc1
  global_load_dwordx4 v[32:35], v43, s[38:39] offset:0 sc1
  s_waitcnt vmcnt(0)
  v_xor_b32 v254, s73, v38
  v_and_b32 v254, s74, v254
  v_xor_b32 v255, s71, v39
  v_or_b32 v255, v255, v254
  v_xor_b32 v254, s73, v22
  v_and_b32 v254, s74, v254
  v_or_b32 v255, v255, v254
  v_xor_b32 v254, s71, v23
  v_or_b32 v255, v255, v254
  v_xor_b32 v254, s73, v26
  v_and_b32 v254, s74, v254
  v_or_b32 v255, v255, v254
  v_xor_b32 v254, s71, v27
  v_or_b32 v255, v255, v254
  v_xor_b32 v254, s73, v30
  v_and_b32 v254, s74, v254
  v_or_b32 v255, v255, v254
  v_xor_b32 v254, s71, v31
  v_or_b32 v255, v255, v254
  v_xor_b32 v254, s73, v34
  v_and_b32 v254, s74, v254
  v_or_b32 v255, v255, v254
  v_xor_b32 v254, s71, v35
  v_or_b32 v255, v255, v254
  v_cmp_ne_u32 vcc, 0, v255
  s_and_b64 exec, exec, vcc
  s_nop 3
  s_cbranch_execz L_gdone_70
  s_sub_u32 s3, s3, 1
  s_cbranch_scc0 L_gpoll_69
L_gdone_70:
  s_mov_b64 exec, s[54:55]
  v_lshlrev_b32 v39, 8, v38
  v_alignbit_b32 v38, v38, v37, 2
  v_alignbit_b32 v37, v37, v36, 12
  v_lshlrev_b32 v36, 10, v36
  v_and_b32 v37, s72, v37
  v_and_b32 v38, s72, v38
  v_and_b32 v39, s72, v39
  s_nop 1
  s_branch L_fin_j_68
L_fin_noffn_67:
  s_mov_b64 s[54:55], exec
  s_mov_b32 s3, 0x40000
L_gpoll_71:
  global_load_dwordx4 v[20:23], v40, s[38:39] offset:0 sc1
  global_load_dwordx4 v[24:27], v41, s[38:39] offset:0 sc1
  global_load_dwordx4 v[28:31], v42, s[38:39] offset:0 sc1
  global_load_dwordx4 v[32:35], v43, s[38:39] offset:0 sc1
  s_waitcnt vmcnt(0)
  v_xor_b32 v254, s73, v22
  v_and_b32 v254, s74, v254
  v_xor_b32 v255, s71, v23
  v_or_b32 v255, v255, v254
  v_xor_b32 v254, s73, v26
  v_and_b32 v254, s74, v254
  v_or_b32 v255, v255, v254
  v_xor_b32 v254, s71, v27
  v_or_b32 v255, v255, v254
  v_xor_b32 v254, s73, v30
  v_and_b32 v254, s74, v254
  v_or_b32 v255, v255, v254
  v_xor_b32 v254, s71, v31
  v_or_b32 v255, v255, v254
  v_xor_b32 v254, s73, v34
  v_and_b32 v254, s74, v254
  v_or_b32 v255, v255, v254
  v_xor_b32 v254, s71, v35
  v_or_b32 v255, v255, v254
  v_cmp_ne_u32 vcc, 0, v255
  s_and_b64 exec, exec, vcc
  s_nop 3
  s_cbranch_execz L_gdone_72
  s_sub_u32 s3, s3, 1
  s_cbranch_scc0 L_gpoll_71
L_gdone_72:
  s_mov_b64 exec, s[54:55]
  v_mov_b32 v36, 0
  v_mov_b32 v37, 0
  v_mov_b32 v38, 0
  v_mov_b32 v39, 0
  s_nop 1
L_fin_j_68:
  v_lshlrev_b32 v23, 8, v22
  v_alignbit_b32 v22, v22, v21, 2
  v_alignbit_b32 v21, v21, v20, 12
  v_lshlrev_b32 v20, 10, v20
  v_and_b32 v21, s72, v21
  v_and_b32 v22, s72, v22
  v_and_b32 v23, s72, v23
  v_lshlrev_b32 v27, 8, v26
  v_alignbit_b32 v26, v26, v25, 2
  v_alignbit_b32 v25, v25, v24, 12
  v_lshlrev_b32 v24, 10, v24
  v_and_b32 v25, s72, v25
  v_and_b32 v26, s72, v26
  v_and_b32 v27, s72, v27
  v_lshlrev_b32 v31, 8, v30
  v_alignbit_b32 v30, v30, v29, 2
  v_alignbit_b32 v29, v29, v28, 12
  v_lshlrev_b32 v28, 10, v28
  v_and_b32 v29, s72, v29
  v_and_b32 v30, s72, v30
  v_and_b32 v31, s72, v31
  v_lshlrev_b32 v35, 8, v34
  v_alignbit_b32 v34, v34, v33, 2
  v_alignbit_b32 v33, v33, v32, 12
  v_lshlrev_b32 v32, 10, v32
  v_and_b32 v33, s72, v33
  v_and_b32 v34, s72, v34
  v_and_b32 v35, s72, v35
  v_add_f32 v20, v20, v24
  v_add_f32 v28, v28, v32
  v_add_f32 v21, v21, v25
  v_add_f32 v29, v29, v33
  v_add_f32 v22, v22, v26
  v_add_f32 v30, v30, v34
  v_add_f32 v23, v23, v27
  v_add_f32 v31, v31, v35
  v_add_f32 v20, v20, v28
  v_add_f32 v21, v21, v29
  v_add_f32 v22, v22, v30
  v_add_f32 v23, v23, v31
  v_add_f32_dpp v20, v20, v20 row_ror:8 row_mask:0xf bank_mask:0xf
  v_add_f32_dpp v36, v36, v36 row_ror:8 row_mask:0xf bank_mask:0xf
  v_add_f32_dpp v21, v21, v21 row_ror:8 row_mask:0xf bank_mask:0xf
  v_add_f32_dpp v37, v37, v37 row_ror:8 row_mask:0xf bank_mask:0xf
  v_add_f32_dpp v22, v22, v22 row_ror:8 row_mask:0xf bank_mask:0xf
  v_add_f32_dpp v38, v38, v38 row_ror:8 row_mask:0xf bank_mask:0xf
  v_add_f32_dpp v23, v23, v23 row_ror:8 row_mask:0xf bank_mask:0xf
  v_add_f32_dpp v39, v39, v39 row_ror:8 row_mask:0xf bank_mask:0xf
  v_lshrrev_b32 v16, 4, v1
  s_lshl_b32 s3, s42, 2
  v_add_u32 v16, s3, v16
  v_lshlrev_b32 v16, 7, v16
  v_and_b32 v17, 7, v1
  v_lshlrev_b32 v17, 4, v17
  v_add_u32 v16, v16, v17
  s_mov_b32 exec_lo, 0x00ff00ff
  s_mov_b32 exec_hi, 0x00ff00ff
  ds_write_b128 v16, v[20:23] offset:13312
  ds_write_b128 v16, v[36:39] offset:17408
  s_mov_b64 exec, -1
  s_waitcnt lgkmcnt(0)
  s_barrier
  s_cmp_lg_u32 s42, 0
  s_cbranch_scc1 L_fin_done_73
  v_and_b32 v16, 31, v1
  v_lshlrev_b32 v16, 2, v16
  v_lshrrev_b32 v17, 5, v1
  v_lshlrev_b32 v17, 12, v17
  v_add_u32 v16, v16, v17
  ds_read_b32 v40, v16 offset:13312
  ds_read_b32 v41, v16 offset:13440
  ds_read_b32 v42, v16 offset:13568
  ds_read_b32 v43, v16 offset:13696
  ds_read_b32 v44, v16 offset:13824
  ds_read_b32 v45, v16 offset:13952
  ds_read_b32 v46, v16 offset:14080
  ds_read_b32 v47, v16 offset:14208
  ds_read_b32 v48, v16 offset:14336
  ds_read_b32 v49, v16 offset:14464
  ds_read_b32 v50, v16 offset:14592
  ds_read_b32 v51, v16 offset:14720
  ds_read_b32 v52, v16 offset:14848
  ds_read_b32 v53, v16 offset:14976
  ds_read_b32 v54, v16 offset:15104
  ds_read_b32 v55, v16 offset:15232
  ds_read_b32 v56, v16 offset:15360
  ds_read_b32 v57, v16 offset:15488
  ds_read_b32 v58, v16 offset:15616
  ds_read_b32 v59, v16 offset:15744
  ds_read_b32 v60, v16 offset:15872
  ds_read_b32 v61, v16 offset:16000
  ds_read_b32 v62, v16 offset:16128
  ds_read_b32 v63, v16 offset:16256
  ds_read_b32 v64, v16 offset:16384
  ds_read_b32 v65, v16 offset:16512
  ds_read_b32 v66, v16 offset:16640
  ds_read_b32 v67, v16 offset:16768
  ds_read_b32 v68, v16 offset:16896
  ds_read_b32 v69, v16 offset:17024
  ds_read_b32 v70, v16 offset:17152
  ds_read_b32 v71, v16 offset:17280
  v_mov_b32 v17, v19
  s_waitcnt lgkmcnt(0)
  v_add_f32 v40, v40, v56
  v_add_f32 v41, v41, v57
  v_add_f32 v42, v42, v58
  v_add_f32 v43, v43, v59
  v_add_f32 v44, v44, v60
  v_add_f32 v45, v45, v61
  v_add_f32 v46, v46, v62
  v_add_f32 v47, v47, v63
  v_add_f32 v48, v48, v64
  v_add_f32 v49, v49, v65
  v_add_f32 v50, v50, v66
  v_add_f32 v51, v51, v67
  v_add_f32 v52, v52, v68
  v_add_f32 v53, v53, v69
  v_add_f32 v54, v54, v70
  v_add_f32 v55, v55, v71
  v_add_f32 v40, v40, v48
  v_add_f32 v41, v41, v49
  v_add_f32 v42, v42, v50
  v_add_f32 v43, v43, v51
  v_add_f32 v44, v44, v52
  v_add_f32 v45, v45, v53
  v_add_f32 v46, v46, v54
  v_add_f32 v47, v47, v55
  v_add_f32 v40, v40, v44
  v_add_f32 v41, v41, v45
  v_add_f32 v42, v42, v46
  v_add_f32 v43, v43, v47
  v_add_f32 v40, v40, v42
  v_add_f32 v41, v41, v43
  v_add_f32 v40, v40, v41
  v_cvt_pk_bf16_f32 v40, v40, v40
  v_and_b32 v40, s70, v40
  v_mov_b32 v41, v40
  v_mov_b32 v42, v40
  s_nop 1
  v_permlane32_swap_b32 v41, v42
  v_mov_b32 v40, v41
  v_mov_b32 v41, v42
  v_mul_f32 v42, 0xbfb8aa3b, v41
  v_exp_f32 v42, v42
  s_nop 0
  v_add_f32 v42, 1.0, v42
  v_rcp_f32 v44, v42
  s_nop 0
  v_mul_f32 v45, v41, v44
  v_fma_f32 v43, -v45, v42, v41
  v_fma_f32 v43, v43, v44, v45
  v_cvt_pk_bf16_f32 v43, v43, v43
  v_and_b32 v43, s70, v43
  v_mul_f32 v43, v40, v43
  v_cvt_pk_bf16_f32 v43, v43, v43
  v_and_b32 v43, s70, v43
  s_waitcnt vmcnt(0)
  v_lshlrev_b32 v18, 16, v18
  v_add_f32 v43, v18, v43
  v_cvt_pk_bf16_f32 v43, v43, v43
  s_mov_b32 exec_lo, -1
  s_mov_b32 exec_hi, 0
  global_store_short v17, v43, s[34:35]
  s_mov_b64 exec, -1
L_fin_done_73:
  s_cmp_lg_u32 s2, 0
  s_cbranch_scc1 L_nofinal_61
  s_cmp_lg_u32 s42, 0
  s_cbranch_scc1 L_nofinal_61
  s_mov_b32 s3, 4194304
  v_mov_b32 v16, s3
  v_mov_b32 v17, s71
  s_mov_b64 exec, 1
  global_store_dword v16, v17, s[38:39] sc1
  s_mov_b64 exec, -1
L_nofinal_61:
L_exit_1:
  s_endpgm
.section .rodata,"a"
.p2align 6
.amdhsa_kernel recurrent_scan__mha_block_cached__geglu_ffn__decode_kernel
  .amdhsa_next_free_vgpr 256
  .amdhsa_next_free_sgpr 102
  .amdhsa_accum_offset 256
  .amdhsa_group_segment_fixed_size 0
  .amdhsa_kernarg_size 96
  .amdhsa_user_sgpr_count 2
  .amdhsa_user_sgpr_kernarg_segment_ptr 1
  .amdhsa_system_sgpr_workgroup_id_x 1
.end_amdhsa_kernel
```
